```python
import torch

def _softmax(x, axis=-1):
    return torch.softmax(x, dim=axis)
def _gelu(x):
    return torch.nn.functional.gelu(x, approximate="tanh")
def _silu(x):
    return torch.nn.functional.silu(x)
def _sigmoid(x):
    return torch.sigmoid(x)
def _layernorm(x, axis=-1, eps=1e-5):
    m = x.mean(dim=axis, keepdim=True)
    v = x.var(dim=axis, keepdim=True, unbiased=False)
    return (x - m) / torch.sqrt(v + eps)
def _scatter_add(tgt, idx, src, axis=0):
    return tgt.clone().index_add_(axis, idx, src)
def _segment_sum(src, seg, n):
    out = torch.zeros((n,) + src.shape[1:], dtype=src.dtype)
    return out.index_add_(0, seg, src)
def _pad(x, pw):
    flat = tuple(v for pair in reversed(pw) for v in pair)
    return torch.nn.functional.pad(x, flat)

kernel_name = 'standalone__geglu_ffn__prompt'

def setup_inputs():

    _w = (lambda a: (lambda t: t.to(torch.bfloat16) if t.is_floating_point() else t)(torch.as_tensor(a)))
    B, S, D, F = 1, 2048, 640, 1728
    return {
        "x": _w((lambda *s: torch.randn(*s, dtype=torch.bfloat16) * 0.05)(B, S, D)),
        "w_gate": _w((lambda *s: torch.randn(*s, dtype=torch.bfloat16) * 0.05)(D, F)),
        "w_up": _w((lambda *s: torch.randn(*s, dtype=torch.bfloat16) * 0.05)(D, F)),
        "w_down": _w((lambda *s: torch.randn(*s, dtype=torch.bfloat16) * 0.05)(F, D)),
    }

def reference(x, w_gate, w_up, w_down):
    return (_gelu(x @ w_gate) * (x @ w_up)) @ w_down
```

```asm
; @launch kernel=standalone__geglu_ffn__prompt_k1_kernel grid=(256,1,1) block=(512,1,1) lds=147456
; @launch kernel=standalone__geglu_ffn__prompt_k2_kernel grid=(256,1,1) block=(256,1,1) lds=61440
.amdgcn_target "amdgcn-amd-amdhsa--gfx950"
.text
.globl standalone__geglu_ffn__prompt_k1_kernel
.p2align 8
.type standalone__geglu_ffn__prompt_k1_kernel,@function
standalone__geglu_ffn__prompt_k1_kernel:
  s_cmp_ge_u32 s2, 256
  s_cbranch_scc1 L1_end
  s_load_dwordx8 s[4:11], s[0:1], 0
  s_load_dwordx2 s[12:13], s[0:1], 48
  v_lshrrev_b32 v20, 6, v0
  v_and_b32 v1, 63, v0
  s_and_b32 s14, s2, 7
  s_lshr_b32 s15, s2, 3
  v_readfirstlane_b32 s32, v20
  s_lshr_b32 s16, s14, 1
  s_cmp_eq_u32 s16, 3
  s_cselect_b32 s17, 24, 28
  v_lshrrev_b32 v20, 3, v1
  v_and_b32 v21, 7, v1
  v_lshrrev_b32 v22, 4, v1
  v_xor_b32 v23, v21, v22
  v_lshlrev_b32 v23, 4, v23
  v_mul_u32_u24 v24, 1280, v20
  s_mul_i32 s40, s32, 40960
  v_add3_u32 v2, v24, v23, s40
  v_xor_b32 v3, 64, v2
  v_and_b32 v23, 1, v22
  v_lshlrev_b32 v23, 1, v23
  v_xor_b32 v23, v21, v23
  v_lshlrev_b32 v23, 4, v23
  v_mul_u32_u24 v24, 3456, v20
  v_add_u32 v4, v24, v23
  v_xor_b32 v5, 64, v4
  s_and_b32 s18, s14, 1
  s_lshl_b32 s18, s18, 2
  s_and_b32 s19, s15, 3
  s_add_u32 s18, s18, s19
  s_mul_i32 s19, s16, 7
  s_lshr_b32 s33, s15, 2
  s_add_u32 s19, s19, s33
  s_and_b32 s33, s32, 1
  s_mul_i32 s34, s18, 327680
  s_lshr_b32 s35, s32, 1
  s_mul_i32 s36, s35, 55296
  s_lshl_b32 s37, s19, 7
  s_add_u32 s36, s36, s37
  s_lshl_b32 s38, s32, 12
  s_lshl_b32 s39, s33, 13
  s_lshl_b32 s40, s35, 11
  s_add_u32 s39, s39, s40
  s_add_u32 s39, s39, 32768
  s_lshl_b32 s52, s16, 1
  s_and_b32 s53, s14, 1
  s_mul_i32 s53, s53, 5
  s_add_u32 s52, s52, s53
  s_cmp_ge_u32 s52, 10
  s_cselect_b32 s53, 10, 0
  s_sub_u32 s52, s52, s53
  s_cmp_ge_u32 s52, 10
  s_cselect_b32 s53, 10, 0
  s_sub_u32 s52, s52, s53
  s_mov_b32 s55, 0xfffffb80
  s_movk_i32 s56, 128
  s_mov_b32 s57, 0xffe1a000
  s_mov_b32 s58, 221184
  s_lshl_b32 s53, s52, 7
  s_add_u32 s34, s34, s53
  s_mul_i32 s53, s52, 221184
  s_add_u32 s36, s36, s53
  s_mov_b32 s22, 2621440
  s_mov_b32 s23, 0x00020000
  s_mov_b32 s26, 2211840
  s_mov_b32 s27, 0x00020000
  s_cmp_eq_u32 s33, 0
  s_waitcnt lgkmcnt(0)
  s_cselect_b32 s24, s6, s8
  s_cselect_b32 s25, s7, s9
  s_mov_b32 s20, s4
  s_and_b32 s21, s5, 0xffff
  s_and_b32 s25, s25, 0xffff
  s_cmp_ge_u32 s15, s17
  s_cbranch_scc1 L1_transposer
  s_add_u32 s50, s38, 0
  s_add_u32 s51, s39, 0
  s_add_u32 m0, s50, 0
  s_add_u32 s42, s34, 0
  buffer_load_dwordx4 v2, s[20:23], s42 offen  lds
  s_add_u32 m0, s50, 1024
  s_add_u32 s43, s34, 10240
  buffer_load_dwordx4 v3, s[20:23], s43 offen  lds
  s_add_u32 m0, s50, 2048
  s_add_u32 s42, s34, 20480
  buffer_load_dwordx4 v2, s[20:23], s42 offen  lds
  s_add_u32 m0, s50, 3072
  s_add_u32 s43, s34, 30720
  buffer_load_dwordx4 v3, s[20:23], s43 offen  lds
  s_add_u32 m0, s51, 0
  s_add_u32 s42, s36, 0
  buffer_load_dwordx4 v4, s[24:27], s42 offen  lds
  s_add_u32 m0, s51, 1024
  s_add_u32 s43, s36, 27648
  buffer_load_dwordx4 v5, s[24:27], s43 offen  lds
  s_add_u32 s52, s52, 1
  s_cmp_eq_u32 s52, 10
  s_cselect_b32 s52, 0, s52
  s_cselect_b32 s53, s55, s56
  s_cselect_b32 s54, s57, s58
  s_add_u32 s34, s34, s53
  s_add_u32 s36, s36, s54
  s_add_u32 s50, s38, 49152
  s_add_u32 s51, s39, 49152
  s_add_u32 m0, s50, 0
  s_add_u32 s42, s34, 0
  buffer_load_dwordx4 v2, s[20:23], s42 offen  lds
  s_add_u32 m0, s50, 1024
  s_add_u32 s43, s34, 10240
  buffer_load_dwordx4 v3, s[20:23], s43 offen  lds
  s_add_u32 m0, s50, 2048
  s_add_u32 s42, s34, 20480
  buffer_load_dwordx4 v2, s[20:23], s42 offen  lds
  s_add_u32 m0, s50, 3072
  s_add_u32 s43, s34, 30720
  buffer_load_dwordx4 v3, s[20:23], s43 offen  lds
  s_add_u32 m0, s51, 0
  s_add_u32 s42, s36, 0
  buffer_load_dwordx4 v4, s[24:27], s42 offen  lds
  s_add_u32 m0, s51, 1024
  s_add_u32 s43, s36, 27648
  buffer_load_dwordx4 v5, s[24:27], s43 offen  lds
  s_add_u32 s52, s52, 1
  s_cmp_eq_u32 s52, 10
  s_cselect_b32 s52, 0, s52
  s_cselect_b32 s53, s55, s56
  s_cselect_b32 s54, s57, s58
  s_add_u32 s34, s34, s53
  s_add_u32 s36, s36, s54
  s_mov_b32 s28, s12
  s_and_b32 s29, s13, 0xffff
  s_mov_b32 s30, 10600448
  s_mov_b32 s31, 0x00020000
  s_and_b32 s40, s32, 3
  s_lshr_b32 s41, s32, 2
  v_and_b32 v20, 15, v1
  v_lshrrev_b32 v21, 4, v1
  v_lshrrev_b32 v22, 1, v20
  v_xor_b32 v22, v21, v22
  v_lshlrev_b32 v22, 4, v22
  v_lshlrev_b32 v23, 7, v20
  s_lshl_b32 s42, s40, 13
  v_add3_u32 v8, v22, v23, s42
  v_xor_b32 v9, 64, v8
  v_bfe_u32 v22, v1, 2, 2
  v_and_b32 v23, 3, v1
  v_lshrrev_b32 v24, 1, v22
  v_and_b32 v25, 1, v21
  v_lshl_add_u32 v24, v25, 1, v24
  v_lshl_add_u32 v25, v21, 3, v22
  v_lshlrev_b32 v25, 7, v25
  v_lshl_add_u32 v25, v23, 3, v25
  v_add_u32 v25, 32768, v25
  s_lshl_b32 s42, s41, 1
  s_add_u32 s43, s42, 0
  v_xor_b32 v26, s43, v24
  v_lshl_add_u32 v10, v26, 5, v25
  s_add_u32 s43, s42, 1
  v_xor_b32 v26, s43, v24
  v_lshl_add_u32 v11, v26, 5, v25
  v_mov_b32 v40, 0
  v_mov_b32 v41, 0
  v_mov_b32 v42, 0
  v_mov_b32 v43, 0
  v_mov_b32 v44, 0
  v_mov_b32 v45, 0
  v_mov_b32 v46, 0
  v_mov_b32 v47, 0
  v_mov_b32 v48, 0
  v_mov_b32 v49, 0
  v_mov_b32 v50, 0
  v_mov_b32 v51, 0
  v_mov_b32 v52, 0
  v_mov_b32 v53, 0
  v_mov_b32 v54, 0
  v_mov_b32 v55, 0
  v_mov_b32 v56, 0
  v_mov_b32 v57, 0
  v_mov_b32 v58, 0
  v_mov_b32 v59, 0
  v_mov_b32 v60, 0
  v_mov_b32 v61, 0
  v_mov_b32 v62, 0
  v_mov_b32 v63, 0
  v_mov_b32 v64, 0
  v_mov_b32 v65, 0
  v_mov_b32 v66, 0
  v_mov_b32 v67, 0
  v_mov_b32 v68, 0
  v_mov_b32 v69, 0
  v_mov_b32 v70, 0
  v_mov_b32 v71, 0
  v_mov_b32 v72, 0
  v_mov_b32 v73, 0
  v_mov_b32 v74, 0
  v_mov_b32 v75, 0
  v_mov_b32 v76, 0
  v_mov_b32 v77, 0
  v_mov_b32 v78, 0
  v_mov_b32 v79, 0
  v_mov_b32 v80, 0
  v_mov_b32 v81, 0
  v_mov_b32 v82, 0
  v_mov_b32 v83, 0
  v_mov_b32 v84, 0
  v_mov_b32 v85, 0
  v_mov_b32 v86, 0
  v_mov_b32 v87, 0
  v_mov_b32 v88, 0
  v_mov_b32 v89, 0
  v_mov_b32 v90, 0
  v_mov_b32 v91, 0
  v_mov_b32 v92, 0
  v_mov_b32 v93, 0
  v_mov_b32 v94, 0
  v_mov_b32 v95, 0
  v_mov_b32 v96, 0
  v_mov_b32 v97, 0
  v_mov_b32 v98, 0
  v_mov_b32 v99, 0
  v_mov_b32 v100, 0
  v_mov_b32 v101, 0
  v_mov_b32 v102, 0
  v_mov_b32 v103, 0
  v_mov_b32 v136, 0
  v_mov_b32 v137, 0
  v_mov_b32 v138, 0
  v_mov_b32 v139, 0
  v_mov_b32 v140, 0
  v_mov_b32 v141, 0
  v_mov_b32 v142, 0
  v_mov_b32 v143, 0
  v_mov_b32 v144, 0
  v_mov_b32 v145, 0
  v_mov_b32 v146, 0
  v_mov_b32 v147, 0
  v_mov_b32 v148, 0
  v_mov_b32 v149, 0
  v_mov_b32 v150, 0
  v_mov_b32 v151, 0
  v_mov_b32 v152, 0
  v_mov_b32 v153, 0
  v_mov_b32 v154, 0
  v_mov_b32 v155, 0
  v_mov_b32 v156, 0
  v_mov_b32 v157, 0
  v_mov_b32 v158, 0
  v_mov_b32 v159, 0
  v_mov_b32 v160, 0
  v_mov_b32 v161, 0
  v_mov_b32 v162, 0
  v_mov_b32 v163, 0
  v_mov_b32 v164, 0
  v_mov_b32 v165, 0
  v_mov_b32 v166, 0
  v_mov_b32 v167, 0
  s_mov_b32 s47, 98304
  s_mov_b32 s48, 0
  s_mov_b32 s49, 0
  s_waitcnt vmcnt(6)
  .p2align 6
L1_loop:
  s_barrier
  v_add_u32 v12, s48, v8
  v_add_u32 v14, s48, v10
  v_add_u32 v13, s48, v9
  v_add_u32 v15, s48, v11
  ds_read_b64_tr_b16 v[120:121], v14 offset:0
  ds_read_b64_tr_b16 v[122:123], v14 offset:512
  ds_read_b64_tr_b16 v[124:125], v15 offset:0
  ds_read_b64_tr_b16 v[126:127], v15 offset:512
  v_mfma_f32_16x16x32_bf16 v[40:43], v[152:155], v[136:139], v[40:43]
  ds_read_b64_tr_b16 v[128:129], v14 offset:8192
  ds_read_b64_tr_b16 v[130:131], v14 offset:8704
  v_mfma_f32_16x16x32_bf16 v[56:59], v[156:159], v[136:139], v[56:59]
  ds_read_b64_tr_b16 v[132:133], v15 offset:8192
  ds_read_b64_tr_b16 v[134:135], v15 offset:8704
  v_mfma_f32_16x16x32_bf16 v[72:75], v[160:163], v[136:139], v[72:75]
  ds_read_b128 v[104:107], v12 offset:0
  ds_read_b128 v[108:111], v12 offset:2048
  ds_read_b128 v[112:115], v12 offset:4096
  v_mfma_f32_16x16x32_bf16 v[88:91], v[164:167], v[136:139], v[88:91]
  ds_read_b128 v[116:119], v12 offset:6144
  s_add_u32 s50, s38, s47
  v_mfma_f32_16x16x32_bf16 v[44:47], v[152:155], v[140:143], v[44:47]
  s_add_u32 s51, s39, s47
  s_cmp_lt_u32 s49, 8
  v_mfma_f32_16x16x32_bf16 v[60:63], v[156:159], v[140:143], v[60:63]
  s_cselect_b32 s34, s34, 0x40000000
  s_cselect_b32 s36, s36, 0x40000000
  s_add_u32 m0, s50, 0
  v_mfma_f32_16x16x32_bf16 v[76:79], v[160:163], v[140:143], v[76:79]
  s_add_u32 s42, s34, 0
  buffer_load_dwordx4 v2, s[20:23], s42 offen  lds
  v_mfma_f32_16x16x32_bf16 v[92:95], v[164:167], v[140:143], v[92:95]
  s_add_u32 m0, s50, 1024
  s_add_u32 s43, s34, 10240
  buffer_load_dwordx4 v3, s[20:23], s43 offen  lds
  v_mfma_f32_16x16x32_bf16 v[48:51], v[152:155], v[144:147], v[48:51]
  s_add_u32 m0, s50, 2048
  s_add_u32 s42, s34, 20480
  v_mfma_f32_16x16x32_bf16 v[64:67], v[156:159], v[144:147], v[64:67]
  buffer_load_dwordx4 v2, s[20:23], s42 offen  lds
  s_add_u32 m0, s50, 3072
  v_mfma_f32_16x16x32_bf16 v[80:83], v[160:163], v[144:147], v[80:83]
  s_add_u32 s43, s34, 30720
  buffer_load_dwordx4 v3, s[20:23], s43 offen  lds
  s_add_u32 m0, s51, 0
  v_mfma_f32_16x16x32_bf16 v[96:99], v[164:167], v[144:147], v[96:99]
  s_add_u32 s42, s36, 0
  buffer_load_dwordx4 v4, s[24:27], s42 offen  lds
  v_mfma_f32_16x16x32_bf16 v[52:55], v[152:155], v[148:151], v[52:55]
  s_add_u32 m0, s51, 1024
  s_add_u32 s43, s36, 27648
  v_mfma_f32_16x16x32_bf16 v[68:71], v[156:159], v[148:151], v[68:71]
  buffer_load_dwordx4 v5, s[24:27], s43 offen  lds
  s_add_u32 s52, s52, 1
  s_cmp_eq_u32 s52, 10
  v_mfma_f32_16x16x32_bf16 v[84:87], v[160:163], v[148:151], v[84:87]
  s_cselect_b32 s52, 0, s52
  s_cselect_b32 s53, s55, s56
  v_mfma_f32_16x16x32_bf16 v[100:103], v[164:167], v[148:151], v[100:103]
  s_cselect_b32 s54, s57, s58
  s_add_u32 s34, s34, s53
  s_add_u32 s36, s36, s54
  s_waitcnt lgkmcnt(0)
  v_mfma_f32_16x16x32_bf16 v[40:43], v[120:123], v[104:107], v[40:43]
  ds_read_b64_tr_b16 v[152:153], v14 offset:4096
  v_mfma_f32_16x16x32_bf16 v[56:59], v[124:127], v[104:107], v[56:59]
  ds_read_b64_tr_b16 v[154:155], v14 offset:4608
  v_mfma_f32_16x16x32_bf16 v[72:75], v[128:131], v[104:107], v[72:75]
  ds_read_b64_tr_b16 v[156:157], v15 offset:4096
  v_mfma_f32_16x16x32_bf16 v[88:91], v[132:135], v[104:107], v[88:91]
  ds_read_b64_tr_b16 v[158:159], v15 offset:4608
  v_mfma_f32_16x16x32_bf16 v[44:47], v[120:123], v[108:111], v[44:47]
  ds_read_b64_tr_b16 v[160:161], v14 offset:12288
  v_mfma_f32_16x16x32_bf16 v[60:63], v[124:127], v[108:111], v[60:63]
  ds_read_b64_tr_b16 v[162:163], v14 offset:12800
  ds_read_b64_tr_b16 v[164:165], v15 offset:12288
  v_mfma_f32_16x16x32_bf16 v[76:79], v[128:131], v[108:111], v[76:79]
  ds_read_b64_tr_b16 v[166:167], v15 offset:12800
  v_mfma_f32_16x16x32_bf16 v[92:95], v[132:135], v[108:111], v[92:95]
  ds_read_b128 v[136:139], v13 offset:0
  v_mfma_f32_16x16x32_bf16 v[48:51], v[120:123], v[112:115], v[48:51]
  ds_read_b128 v[140:143], v13 offset:2048
  v_mfma_f32_16x16x32_bf16 v[64:67], v[124:127], v[112:115], v[64:67]
  ds_read_b128 v[144:147], v13 offset:4096
  v_mfma_f32_16x16x32_bf16 v[80:83], v[128:131], v[112:115], v[80:83]
  ds_read_b128 v[148:151], v13 offset:6144
  s_add_u32 s47, s47, 49152
  v_mfma_f32_16x16x32_bf16 v[96:99], v[132:135], v[112:115], v[96:99]
  s_cmp_eq_u32 s47, 147456
  v_mfma_f32_16x16x32_bf16 v[52:55], v[120:123], v[116:119], v[52:55]
  s_cselect_b32 s47, 0, s47
  v_mfma_f32_16x16x32_bf16 v[68:71], v[124:127], v[116:119], v[68:71]
  s_add_u32 s48, s48, 49152
  v_mfma_f32_16x16x32_bf16 v[84:87], v[128:131], v[116:119], v[84:87]
  s_cmp_eq_u32 s48, 147456
  v_mfma_f32_16x16x32_bf16 v[100:103], v[132:135], v[116:119], v[100:103]
  s_cselect_b32 s48, 0, s48
  s_add_u32 s49, s49, 1
  s_cmp_lt_u32 s49, 10
  s_waitcnt vmcnt(6) lgkmcnt(0)
  s_cbranch_scc1 L1_loop
  v_mfma_f32_16x16x32_bf16 v[40:43], v[152:155], v[136:139], v[40:43]
  v_mfma_f32_16x16x32_bf16 v[56:59], v[156:159], v[136:139], v[56:59]
  v_mfma_f32_16x16x32_bf16 v[72:75], v[160:163], v[136:139], v[72:75]
  v_mfma_f32_16x16x32_bf16 v[88:91], v[164:167], v[136:139], v[88:91]
  v_mfma_f32_16x16x32_bf16 v[44:47], v[152:155], v[140:143], v[44:47]
  v_mfma_f32_16x16x32_bf16 v[60:63], v[156:159], v[140:143], v[60:63]
  v_mfma_f32_16x16x32_bf16 v[76:79], v[160:163], v[140:143], v[76:79]
  v_mfma_f32_16x16x32_bf16 v[92:95], v[164:167], v[140:143], v[92:95]
  v_mfma_f32_16x16x32_bf16 v[48:51], v[152:155], v[144:147], v[48:51]
  v_mfma_f32_16x16x32_bf16 v[64:67], v[156:159], v[144:147], v[64:67]
  v_mfma_f32_16x16x32_bf16 v[80:83], v[160:163], v[144:147], v[80:83]
  v_mfma_f32_16x16x32_bf16 v[96:99], v[164:167], v[144:147], v[96:99]
  v_mfma_f32_16x16x32_bf16 v[52:55], v[152:155], v[148:151], v[52:55]
  v_mfma_f32_16x16x32_bf16 v[68:71], v[156:159], v[148:151], v[68:71]
  v_mfma_f32_16x16x32_bf16 v[84:87], v[160:163], v[148:151], v[84:87]
  v_mfma_f32_16x16x32_bf16 v[100:103], v[164:167], v[148:151], v[100:103]
  s_lshl_b32 s42, s18, 4
  s_lshl_b32 s43, s40, 2
  s_add_u32 s42, s42, s43
  s_mul_i32 s42, s42, 54
  s_lshl_b32 s43, s19, 1
  s_add_u32 s42, s42, s43
  s_add_u32 s42, s42, s41
  s_lshl_b32 s42, s42, 10
  v_lshlrev_b32 v20, 4, v1
  v_mov_b32 v16, 0xc0135761
  v_mov_b32 v17, 0xc0135761
  v_mov_b32 v18, 0xbdd2d3e8
  v_mov_b32 v19, 0xbdd2d3e8
  s_nop 3
  v_pk_mul_f32 v[104:105], v[40:41], v[40:41]
  v_pk_mul_f32 v[108:109], v[42:43], v[42:43]
  v_pk_mul_f32 v[112:113], v[56:57], v[56:57]
  v_pk_mul_f32 v[116:117], v[58:59], v[58:59]
  v_pk_fma_f32 v[104:105], v[104:105], v[18:19], v[16:17]
  v_pk_fma_f32 v[108:109], v[108:109], v[18:19], v[16:17]
  v_pk_fma_f32 v[112:113], v[112:113], v[18:19], v[16:17]
  v_pk_fma_f32 v[116:117], v[116:117], v[18:19], v[16:17]
  v_pk_mul_f32 v[104:105], v[104:105], v[40:41]
  v_pk_mul_f32 v[108:109], v[108:109], v[42:43]
  v_pk_mul_f32 v[112:113], v[112:113], v[56:57]
  v_pk_mul_f32 v[116:117], v[116:117], v[58:59]
  v_exp_f32 v104, v104
  v_exp_f32 v105, v105
  v_exp_f32 v108, v108
  v_exp_f32 v109, v109
  v_exp_f32 v112, v112
  v_exp_f32 v113, v113
  v_exp_f32 v116, v116
  v_exp_f32 v117, v117
  v_pk_mul_f32 v[106:107], v[40:41], v[72:73]
  v_pk_mul_f32 v[110:111], v[42:43], v[74:75]
  v_pk_mul_f32 v[114:115], v[56:57], v[88:89]
  v_pk_mul_f32 v[118:119], v[58:59], v[90:91]
  v_pk_add_f32 v[104:105], v[104:105], 1.0 op_sel_hi:[1,0]
  v_pk_add_f32 v[108:109], v[108:109], 1.0 op_sel_hi:[1,0]
  v_pk_add_f32 v[112:113], v[112:113], 1.0 op_sel_hi:[1,0]
  v_pk_add_f32 v[116:117], v[116:117], 1.0 op_sel_hi:[1,0]
  v_rcp_f32 v104, v104
  v_rcp_f32 v105, v105
  v_rcp_f32 v108, v108
  v_rcp_f32 v109, v109
  v_rcp_f32 v112, v112
  v_rcp_f32 v113, v113
  v_rcp_f32 v116, v116
  v_rcp_f32 v117, v117
  s_nop 0
  v_pk_mul_f32 v[104:105], v[104:105], v[106:107]
  v_pk_mul_f32 v[108:109], v[108:109], v[110:111]
  v_pk_mul_f32 v[112:113], v[112:113], v[114:115]
  v_pk_mul_f32 v[116:117], v[116:117], v[118:119]
  v_cvt_pk_bf16_f32 v24, v104, v105
  v_cvt_pk_bf16_f32 v25, v108, v109
  v_cvt_pk_bf16_f32 v26, v112, v113
  v_cvt_pk_bf16_f32 v27, v116, v117
  s_add_u32 s43, s42, 0
  buffer_store_dwordx4 v[24:27], v20, s[28:31], s43 offen sc1
  v_pk_mul_f32 v[104:105], v[44:45], v[44:45]
  v_pk_mul_f32 v[108:109], v[46:47], v[46:47]
  v_pk_mul_f32 v[112:113], v[60:61], v[60:61]
  v_pk_mul_f32 v[116:117], v[62:63], v[62:63]
  v_pk_fma_f32 v[104:105], v[104:105], v[18:19], v[16:17]
  v_pk_fma_f32 v[108:109], v[108:109], v[18:19], v[16:17]
  v_pk_fma_f32 v[112:113], v[112:113], v[18:19], v[16:17]
  v_pk_fma_f32 v[116:117], v[116:117], v[18:19], v[16:17]
  v_pk_mul_f32 v[104:105], v[104:105], v[44:45]
  v_pk_mul_f32 v[108:109], v[108:109], v[46:47]
  v_pk_mul_f32 v[112:113], v[112:113], v[60:61]
  v_pk_mul_f32 v[116:117], v[116:117], v[62:63]
  v_exp_f32 v104, v104
  v_exp_f32 v105, v105
  v_exp_f32 v108, v108
  v_exp_f32 v109, v109
  v_exp_f32 v112, v112
  v_exp_f32 v113, v113
  v_exp_f32 v116, v116
  v_exp_f32 v117, v117
  v_pk_mul_f32 v[106:107], v[44:45], v[76:77]
  v_pk_mul_f32 v[110:111], v[46:47], v[78:79]
  v_pk_mul_f32 v[114:115], v[60:61], v[92:93]
  v_pk_mul_f32 v[118:119], v[62:63], v[94:95]
  v_pk_add_f32 v[104:105], v[104:105], 1.0 op_sel_hi:[1,0]
  v_pk_add_f32 v[108:109], v[108:109], 1.0 op_sel_hi:[1,0]
  v_pk_add_f32 v[112:113], v[112:113], 1.0 op_sel_hi:[1,0]
  v_pk_add_f32 v[116:117], v[116:117], 1.0 op_sel_hi:[1,0]
  v_rcp_f32 v104, v104
  v_rcp_f32 v105, v105
  v_rcp_f32 v108, v108
  v_rcp_f32 v109, v109
  v_rcp_f32 v112, v112
  v_rcp_f32 v113, v113
  v_rcp_f32 v116, v116
  v_rcp_f32 v117, v117
  s_nop 0
  v_pk_mul_f32 v[104:105], v[104:105], v[106:107]
  v_pk_mul_f32 v[108:109], v[108:109], v[110:111]
  v_pk_mul_f32 v[112:113], v[112:113], v[114:115]
  v_pk_mul_f32 v[116:117], v[116:117], v[118:119]
  v_cvt_pk_bf16_f32 v28, v104, v105
  v_cvt_pk_bf16_f32 v29, v108, v109
  v_cvt_pk_bf16_f32 v30, v112, v113
  v_cvt_pk_bf16_f32 v31, v116, v117
  s_add_u32 s43, s42, 55296
  buffer_store_dwordx4 v[28:31], v20, s[28:31], s43 offen sc1
  v_pk_mul_f32 v[104:105], v[48:49], v[48:49]
  v_pk_mul_f32 v[108:109], v[50:51], v[50:51]
  v_pk_mul_f32 v[112:113], v[64:65], v[64:65]
  v_pk_mul_f32 v[116:117], v[66:67], v[66:67]
  v_pk_fma_f32 v[104:105], v[104:105], v[18:19], v[16:17]
  v_pk_fma_f32 v[108:109], v[108:109], v[18:19], v[16:17]
  v_pk_fma_f32 v[112:113], v[112:113], v[18:19], v[16:17]
  v_pk_fma_f32 v[116:117], v[116:117], v[18:19], v[16:17]
  v_pk_mul_f32 v[104:105], v[104:105], v[48:49]
  v_pk_mul_f32 v[108:109], v[108:109], v[50:51]
  v_pk_mul_f32 v[112:113], v[112:113], v[64:65]
  v_pk_mul_f32 v[116:117], v[116:117], v[66:67]
  v_exp_f32 v104, v104
  v_exp_f32 v105, v105
  v_exp_f32 v108, v108
  v_exp_f32 v109, v109
  v_exp_f32 v112, v112
  v_exp_f32 v113, v113
  v_exp_f32 v116, v116
  v_exp_f32 v117, v117
  v_pk_mul_f32 v[106:107], v[48:49], v[80:81]
  v_pk_mul_f32 v[110:111], v[50:51], v[82:83]
  v_pk_mul_f32 v[114:115], v[64:65], v[96:97]
  v_pk_mul_f32 v[118:119], v[66:67], v[98:99]
  v_pk_add_f32 v[104:105], v[104:105], 1.0 op_sel_hi:[1,0]
  v_pk_add_f32 v[108:109], v[108:109], 1.0 op_sel_hi:[1,0]
  v_pk_add_f32 v[112:113], v[112:113], 1.0 op_sel_hi:[1,0]
  v_pk_add_f32 v[116:117], v[116:117], 1.0 op_sel_hi:[1,0]
  v_rcp_f32 v104, v104
  v_rcp_f32 v105, v105
  v_rcp_f32 v108, v108
  v_rcp_f32 v109, v109
  v_rcp_f32 v112, v112
  v_rcp_f32 v113, v113
  v_rcp_f32 v116, v116
  v_rcp_f32 v117, v117
  s_nop 0
  v_pk_mul_f32 v[104:105], v[104:105], v[106:107]
  v_pk_mul_f32 v[108:109], v[108:109], v[110:111]
  v_pk_mul_f32 v[112:113], v[112:113], v[114:115]
  v_pk_mul_f32 v[116:117], v[116:117], v[118:119]
  v_cvt_pk_bf16_f32 v24, v104, v105
  v_cvt_pk_bf16_f32 v25, v108, v109
  v_cvt_pk_bf16_f32 v26, v112, v113
  v_cvt_pk_bf16_f32 v27, v116, v117
  s_add_u32 s43, s42, 110592
  buffer_store_dwordx4 v[24:27], v20, s[28:31], s43 offen sc1
  v_pk_mul_f32 v[104:105], v[52:53], v[52:53]
  v_pk_mul_f32 v[108:109], v[54:55], v[54:55]
  v_pk_mul_f32 v[112:113], v[68:69], v[68:69]
  v_pk_mul_f32 v[116:117], v[70:71], v[70:71]
  v_pk_fma_f32 v[104:105], v[104:105], v[18:19], v[16:17]
  v_pk_fma_f32 v[108:109], v[108:109], v[18:19], v[16:17]
  v_pk_fma_f32 v[112:113], v[112:113], v[18:19], v[16:17]
  v_pk_fma_f32 v[116:117], v[116:117], v[18:19], v[16:17]
  v_pk_mul_f32 v[104:105], v[104:105], v[52:53]
  v_pk_mul_f32 v[108:109], v[108:109], v[54:55]
  v_pk_mul_f32 v[112:113], v[112:113], v[68:69]
  v_pk_mul_f32 v[116:117], v[116:117], v[70:71]
  v_exp_f32 v104, v104
  v_exp_f32 v105, v105
  v_exp_f32 v108, v108
  v_exp_f32 v109, v109
  v_exp_f32 v112, v112
  v_exp_f32 v113, v113
  v_exp_f32 v116, v116
  v_exp_f32 v117, v117
  v_pk_mul_f32 v[106:107], v[52:53], v[84:85]
  v_pk_mul_f32 v[110:111], v[54:55], v[86:87]
  v_pk_mul_f32 v[114:115], v[68:69], v[100:101]
  v_pk_mul_f32 v[118:119], v[70:71], v[102:103]
  v_pk_add_f32 v[104:105], v[104:105], 1.0 op_sel_hi:[1,0]
  v_pk_add_f32 v[108:109], v[108:109], 1.0 op_sel_hi:[1,0]
  v_pk_add_f32 v[112:113], v[112:113], 1.0 op_sel_hi:[1,0]
  v_pk_add_f32 v[116:117], v[116:117], 1.0 op_sel_hi:[1,0]
  v_rcp_f32 v104, v104
  v_rcp_f32 v105, v105
  v_rcp_f32 v108, v108
  v_rcp_f32 v109, v109
  v_rcp_f32 v112, v112
  v_rcp_f32 v113, v113
  v_rcp_f32 v116, v116
  v_rcp_f32 v117, v117
  s_nop 0
  v_pk_mul_f32 v[104:105], v[104:105], v[106:107]
  v_pk_mul_f32 v[108:109], v[108:109], v[110:111]
  v_pk_mul_f32 v[112:113], v[112:113], v[114:115]
  v_pk_mul_f32 v[116:117], v[116:117], v[118:119]
  v_cvt_pk_bf16_f32 v28, v104, v105
  v_cvt_pk_bf16_f32 v29, v108, v109
  v_cvt_pk_bf16_f32 v30, v112, v113
  v_cvt_pk_bf16_f32 v31, v116, v117
  s_add_u32 s43, s42, 165888
  buffer_store_dwordx4 v[28:31], v20, s[28:31], s43 offen sc1
  s_endpgm
L1_transposer:
  s_mov_b32 s28, s12
  s_and_b32 s29, s13, 0xffff
  s_mov_b32 s30, 10600448
  s_mov_b32 s31, 0x00020000
  s_lshl_b32 s18, s14, 2
  s_add_u32 s18, s18, s15
  s_sub_u32 s18, s18, 28
  s_lshl_b32 s19, s14, 3
  s_add_u32 s19, s19, s15
  s_sub_u32 s19, s19, 48
  s_cmp_lt_u32 s14, 6
  s_cselect_b32 s18, s18, s19
  s_mov_b32 s20, s10
  s_and_b32 s21, s11, 0xffff
  s_mov_b32 s22, 2211840
  s_mov_b32 s23, 0x00020000
  s_mul_i32 s33, s32, 160
  s_mov_b32 s34, 52429
  v_add_u32 v20, 0, v1
  v_mul_lo_u32 v21, v20, s34
  v_lshrrev_b32 v21, 19, v21
  v_mul_u32_u24 v22, 10, v21
  v_sub_u32 v22, v20, v22
  v_mul_u32_u24 v21, 1280, v21
  v_lshlrev_b32 v22, 4, v22
  v_add3_u32 v2, v21, v22, s33
  v_add_u32 v20, 64, v1
  v_mul_lo_u32 v21, v20, s34
  v_lshrrev_b32 v21, 19, v21
  v_mul_u32_u24 v22, 10, v21
  v_sub_u32 v22, v20, v22
  v_mul_u32_u24 v21, 1280, v21
  v_lshlrev_b32 v22, 4, v22
  v_add3_u32 v3, v21, v22, s33
  v_add_u32 v20, 128, v1
  v_mul_lo_u32 v21, v20, s34
  v_lshrrev_b32 v21, 19, v21
  v_mul_u32_u24 v22, 10, v21
  v_sub_u32 v22, v20, v22
  v_mul_u32_u24 v21, 1280, v21
  v_lshlrev_b32 v22, 4, v22
  v_add3_u32 v4, v21, v22, s33
  v_add_u32 v20, 192, v1
  v_mul_lo_u32 v21, v20, s34
  v_lshrrev_b32 v21, 19, v21
  v_mul_u32_u24 v22, 10, v21
  v_sub_u32 v22, v20, v22
  v_mul_u32_u24 v21, 1280, v21
  v_lshlrev_b32 v22, 4, v22
  v_add3_u32 v5, v21, v22, s33
  v_add_u32 v20, 256, v1
  v_mul_lo_u32 v21, v20, s34
  v_lshrrev_b32 v21, 19, v21
  v_mul_u32_u24 v22, 10, v21
  v_sub_u32 v22, v20, v22
  v_mul_u32_u24 v21, 1280, v21
  v_lshlrev_b32 v22, 4, v22
  v_add3_u32 v6, v21, v22, s33
  v_lshrrev_b32 v21, 2, v1
  v_mul_u32_u24 v21, 160, v21
  v_and_b32 v22, 3, v1
  v_lshlrev_b32 v22, 3, v22
  s_mul_i32 s35, s32, 5120
  v_add3_u32 v7, v21, v22, s35
  v_lshlrev_b32 v8, 4, v1
  s_mov_b32 s36, 0
L1_tr_loop:
  s_mul_i32 s37, s18, 40960
  s_add_u32 m0, s35, 0
  s_nop 0
  buffer_load_dwordx4 v2, s[20:23], s37 offen  lds
  s_add_u32 m0, s35, 1024
  s_nop 0
  buffer_load_dwordx4 v3, s[20:23], s37 offen  lds
  s_add_u32 m0, s35, 2048
  s_nop 0
  buffer_load_dwordx4 v4, s[20:23], s37 offen  lds
  s_add_u32 m0, s35, 3072
  s_nop 0
  buffer_load_dwordx4 v5, s[20:23], s37 offen  lds
  s_add_u32 m0, s35, 4096
  s_nop 0
  buffer_load_dwordx4 v6, s[20:23], s37 offen  lds
  s_waitcnt vmcnt(0)
  ds_read_b64_tr_b16 v[24:25], v7 offset:0
  ds_read_b64_tr_b16 v[26:27], v7 offset:2560
  ds_read_b64_tr_b16 v[28:29], v7 offset:32
  ds_read_b64_tr_b16 v[30:31], v7 offset:2592
  ds_read_b64_tr_b16 v[32:33], v7 offset:64
  ds_read_b64_tr_b16 v[34:35], v7 offset:2624
  ds_read_b64_tr_b16 v[36:37], v7 offset:96
  ds_read_b64_tr_b16 v[38:39], v7 offset:2656
  ds_read_b64_tr_b16 v[40:41], v7 offset:128
  ds_read_b64_tr_b16 v[42:43], v7 offset:2688
  s_mul_i32 s38, s32, 270
  s_add_u32 s38, s38, s18
  s_lshl_b32 s38, s38, 10
  s_waitcnt lgkmcnt(0)
  s_add_u32 s39, s38, 8388608
  buffer_store_dwordx4 v[24:27], v8, s[28:31], s39 offen sc1
  s_add_u32 s39, s38, 8443904
  buffer_store_dwordx4 v[28:31], v8, s[28:31], s39 offen sc1
  s_add_u32 s39, s38, 8499200
  buffer_store_dwordx4 v[32:35], v8, s[28:31], s39 offen sc1
  s_add_u32 s39, s38, 8554496
  buffer_store_dwordx4 v[36:39], v8, s[28:31], s39 offen sc1
  s_add_u32 s39, s38, 8609792
  buffer_store_dwordx4 v[40:43], v8, s[28:31], s39 offen sc1
  s_waitcnt vmcnt(0)
  s_add_u32 s18, s18, 40
  s_cmp_lt_u32 s18, 54
  s_cbranch_scc1 L1_tr_loop
L1_end:
  s_endpgm
.globl standalone__geglu_ffn__prompt_k2_kernel
.p2align 8
.type standalone__geglu_ffn__prompt_k2_kernel,@function
standalone__geglu_ffn__prompt_k2_kernel:
  s_cmp_ge_u32 s2, 256
  s_cbranch_scc1 L2_end
  s_load_dwordx2 s[4:5], s[0:1], 32
  s_load_dwordx2 s[6:7], s[0:1], 48
  v_lshrrev_b32 v2, 6, v0
  v_and_b32 v1, 63, v0
  s_and_b32 s14, s2, 7
  s_lshr_b32 s15, s2, 3
  v_readfirstlane_b32 s32, v2
  s_and_b32 s16, s14, 1
  s_lshl_b32 s16, s16, 2
  s_and_b32 s17, s15, 3
  s_add_u32 s16, s16, s17
  s_lshr_b32 s17, s14, 1
  s_lshl_b32 s17, s17, 3
  s_lshr_b32 s18, s15, 2
  s_add_u32 s17, s17, s18
  s_mul_i32 s18, s32, 14
  s_cmp_eq_u32 s32, 3
  s_cselect_b32 s19, 1, 0
  s_sub_u32 s18, s18, s19
  s_add_u32 s19, s32, 0
  s_and_b32 s19, s19, 3
  s_lshl_b32 s20, s17, 2
  s_add_u32 s19, s19, s20
  s_mul_i32 s19, s19, 54
  s_add_u32 s19, s19, s18
  s_lshl_b32 s40, s19, 10
  s_add_u32 s19, s32, 1
  s_and_b32 s19, s19, 3
  s_lshl_b32 s20, s17, 2
  s_add_u32 s19, s19, s20
  s_mul_i32 s19, s19, 54
  s_add_u32 s19, s19, s18
  s_lshl_b32 s41, s19, 10
  s_add_u32 s19, s32, 2
  s_and_b32 s19, s19, 3
  s_lshl_b32 s20, s17, 2
  s_add_u32 s19, s19, s20
  s_mul_i32 s19, s19, 54
  s_add_u32 s19, s19, s18
  s_lshl_b32 s42, s19, 10
  s_add_u32 s19, s32, 3
  s_and_b32 s19, s19, 3
  s_lshl_b32 s20, s17, 2
  s_add_u32 s19, s19, s20
  s_mul_i32 s19, s19, 54
  s_add_u32 s19, s19, s18
  s_lshl_b32 s43, s19, 10
  s_mul_i32 s19, s16, 5
  s_add_u32 s19, s19, 0
  s_mul_i32 s19, s19, 54
  s_add_u32 s19, s19, s18
  s_lshl_b32 s19, s19, 10
  s_add_u32 s44, s19, 8388608
  s_mul_i32 s19, s16, 5
  s_add_u32 s19, s19, 1
  s_mul_i32 s19, s19, 54
  s_add_u32 s19, s19, s18
  s_lshl_b32 s19, s19, 10
  s_add_u32 s45, s19, 8388608
  s_mul_i32 s19, s16, 5
  s_add_u32 s19, s19, 2
  s_mul_i32 s19, s19, 54
  s_add_u32 s19, s19, s18
  s_lshl_b32 s19, s19, 10
  s_add_u32 s46, s19, 8388608
  s_mul_i32 s19, s16, 5
  s_add_u32 s19, s19, 3
  s_mul_i32 s19, s19, 54
  s_add_u32 s19, s19, s18
  s_lshl_b32 s19, s19, 10
  s_add_u32 s47, s19, 8388608
  s_mul_i32 s19, s16, 5
  s_add_u32 s19, s19, 4
  s_mul_i32 s19, s19, 54
  s_add_u32 s19, s19, s18
  s_lshl_b32 s19, s19, 10
  s_add_u32 s48, s19, 8388608
  v_lshlrev_b32 v3, 4, v1
  s_waitcnt lgkmcnt(0)
  s_mov_b32 s8, s6
  s_and_b32 s9, s7, 0xffff
  s_mov_b32 s10, 10600448
  s_mov_b32 s11, 0x00020000
  s_mov_b32 s24, s4
  s_and_b32 s25, s5, 0xffff
  s_mov_b32 s26, 2621440
  s_mov_b32 s27, 0x00020000
  s_cmp_lt_u32 s32, 2
  s_cselect_b32 s51, 14, 13
  s_lshl_b32 s51, s51, 10
  s_mov_b32 s50, 0
  s_add_u32 s52, s44, s50
  buffer_load_dwordx4 v[112:115], v3, s[8:11], s52 offen
  s_add_u32 s53, s45, s50
  buffer_load_dwordx4 v[116:119], v3, s[8:11], s53 offen
  s_add_u32 s52, s46, s50
  buffer_load_dwordx4 v[120:123], v3, s[8:11], s52 offen
  s_add_u32 s53, s47, s50
  buffer_load_dwordx4 v[124:127], v3, s[8:11], s53 offen
  s_add_u32 s52, s48, s50
  buffer_load_dwordx4 v[128:131], v3, s[8:11], s52 offen
  s_add_u32 s52, s40, s50
  buffer_load_dwordx4 v[96:99], v3, s[8:11], s52 offen
  s_add_u32 s53, s41, s50
  buffer_load_dwordx4 v[100:103], v3, s[8:11], s53 offen
  s_add_u32 s52, s42, s50
  buffer_load_dwordx4 v[104:107], v3, s[8:11], s52 offen
  s_add_u32 s53, s43, s50
  buffer_load_dwordx4 v[108:111], v3, s[8:11], s53 offen
  s_add_u32 s50, s50, 1024
  s_cmp_eq_u32 s50, s51
  s_cselect_b32 s50, 0, s50
  s_add_u32 s52, s44, s50
  buffer_load_dwordx4 v[148:151], v3, s[8:11], s52 offen
  s_add_u32 s53, s45, s50
  buffer_load_dwordx4 v[152:155], v3, s[8:11], s53 offen
  s_add_u32 s52, s46, s50
  buffer_load_dwordx4 v[156:159], v3, s[8:11], s52 offen
  s_add_u32 s53, s47, s50
  buffer_load_dwordx4 v[160:163], v3, s[8:11], s53 offen
  s_add_u32 s52, s48, s50
  buffer_load_dwordx4 v[164:167], v3, s[8:11], s52 offen
  s_add_u32 s52, s40, s50
  buffer_load_dwordx4 v[132:135], v3, s[8:11], s52 offen
  s_add_u32 s53, s41, s50
  buffer_load_dwordx4 v[136:139], v3, s[8:11], s53 offen
  s_add_u32 s52, s42, s50
  buffer_load_dwordx4 v[140:143], v3, s[8:11], s52 offen
  s_add_u32 s53, s43, s50
  buffer_load_dwordx4 v[144:147], v3, s[8:11], s53 offen
  s_add_u32 s50, s50, 1024
  s_cmp_eq_u32 s50, s51
  s_cselect_b32 s50, 0, s50
  s_add_u32 s52, s44, s50
  buffer_load_dwordx4 v[184:187], v3, s[8:11], s52 offen
  s_add_u32 s53, s45, s50
  buffer_load_dwordx4 v[188:191], v3, s[8:11], s53 offen
  s_add_u32 s52, s46, s50
  buffer_load_dwordx4 v[192:195], v3, s[8:11], s52 offen
  s_add_u32 s53, s47, s50
  buffer_load_dwordx4 v[196:199], v3, s[8:11], s53 offen
  s_add_u32 s52, s48, s50
  buffer_load_dwordx4 v[200:203], v3, s[8:11], s52 offen
  s_add_u32 s52, s40, s50
  buffer_load_dwordx4 v[168:171], v3, s[8:11], s52 offen
  s_add_u32 s53, s41, s50
  buffer_load_dwordx4 v[172:175], v3, s[8:11], s53 offen
  s_add_u32 s52, s42, s50
  buffer_load_dwordx4 v[176:179], v3, s[8:11], s52 offen
  s_add_u32 s53, s43, s50
  buffer_load_dwordx4 v[180:183], v3, s[8:11], s53 offen
  s_add_u32 s50, s50, 1024
  s_cmp_eq_u32 s50, s51
  s_cselect_b32 s50, 0, s50
  s_add_u32 s52, s44, s50
  buffer_load_dwordx4 v[220:223], v3, s[8:11], s52 offen
  s_add_u32 s53, s45, s50
  buffer_load_dwordx4 v[224:227], v3, s[8:11], s53 offen
  s_add_u32 s52, s46, s50
  buffer_load_dwordx4 v[228:231], v3, s[8:11], s52 offen
  s_add_u32 s53, s47, s50
  buffer_load_dwordx4 v[232:235], v3, s[8:11], s53 offen
  s_add_u32 s52, s48, s50
  buffer_load_dwordx4 v[236:239], v3, s[8:11], s52 offen
  s_add_u32 s52, s40, s50
  buffer_load_dwordx4 v[204:207], v3, s[8:11], s52 offen
  s_add_u32 s53, s41, s50
  buffer_load_dwordx4 v[208:211], v3, s[8:11], s53 offen
  s_add_u32 s52, s42, s50
  buffer_load_dwordx4 v[212:215], v3, s[8:11], s52 offen
  s_add_u32 s53, s43, s50
  buffer_load_dwordx4 v[216:219], v3, s[8:11], s53 offen
  s_add_u32 s50, s50, 1024
  s_cmp_eq_u32 s50, s51
  s_cselect_b32 s50, 0, s50
  v_mov_b32 v16, 0
  v_mov_b32 v17, 0
  v_mov_b32 v18, 0
  v_mov_b32 v19, 0
  v_mov_b32 v20, 0
  v_mov_b32 v21, 0
  v_mov_b32 v22, 0
  v_mov_b32 v23, 0
  v_mov_b32 v24, 0
  v_mov_b32 v25, 0
  v_mov_b32 v26, 0
  v_mov_b32 v27, 0
  v_mov_b32 v28, 0
  v_mov_b32 v29, 0
  v_mov_b32 v30, 0
  v_mov_b32 v31, 0
  v_mov_b32 v32, 0
  v_mov_b32 v33, 0
  v_mov_b32 v34, 0
  v_mov_b32 v35, 0
  v_mov_b32 v36, 0
  v_mov_b32 v37, 0
  v_mov_b32 v38, 0
  v_mov_b32 v39, 0
  v_mov_b32 v40, 0
  v_mov_b32 v41, 0
  v_mov_b32 v42, 0
  v_mov_b32 v43, 0
  v_mov_b32 v44, 0
  v_mov_b32 v45, 0
  v_mov_b32 v46, 0
  v_mov_b32 v47, 0
  v_mov_b32 v48, 0
  v_mov_b32 v49, 0
  v_mov_b32 v50, 0
  v_mov_b32 v51, 0
  v_mov_b32 v52, 0
  v_mov_b32 v53, 0
  v_mov_b32 v54, 0
  v_mov_b32 v55, 0
  v_mov_b32 v56, 0
  v_mov_b32 v57, 0
  v_mov_b32 v58, 0
  v_mov_b32 v59, 0
  v_mov_b32 v60, 0
  v_mov_b32 v61, 0
  v_mov_b32 v62, 0
  v_mov_b32 v63, 0
  v_mov_b32 v64, 0
  v_mov_b32 v65, 0
  v_mov_b32 v66, 0
  v_mov_b32 v67, 0
  v_mov_b32 v68, 0
  v_mov_b32 v69, 0
  v_mov_b32 v70, 0
  v_mov_b32 v71, 0
  v_mov_b32 v72, 0
  v_mov_b32 v73, 0
  v_mov_b32 v74, 0
  v_mov_b32 v75, 0
  v_mov_b32 v76, 0
  v_mov_b32 v77, 0
  v_mov_b32 v78, 0
  v_mov_b32 v79, 0
  v_mov_b32 v80, 0
  v_mov_b32 v81, 0
  v_mov_b32 v82, 0
  v_mov_b32 v83, 0
  v_mov_b32 v84, 0
  v_mov_b32 v85, 0
  v_mov_b32 v86, 0
  v_mov_b32 v87, 0
  v_mov_b32 v88, 0
  v_mov_b32 v89, 0
  v_mov_b32 v90, 0
  v_mov_b32 v91, 0
  v_mov_b32 v92, 0
  v_mov_b32 v93, 0
  v_mov_b32 v94, 0
  v_mov_b32 v95, 0
  s_add_u32 s19, s32, 1
  s_and_b32 s19, s19, 3
  s_mul_i32 s19, s19, 15360
  s_add_u32 s19, s19, 0
  v_add_u32 v4, s19, v3
  s_add_u32 s19, s32, 2
  s_and_b32 s19, s19, 3
  s_mul_i32 s19, s19, 15360
  s_add_u32 s19, s19, 5120
  v_add_u32 v5, s19, v3
  s_add_u32 s19, s32, 3
  s_and_b32 s19, s19, 3
  s_mul_i32 s19, s19, 15360
  s_add_u32 s19, s19, 10240
  v_add_u32 v6, s19, v3
  s_mul_i32 s19, s32, 15360
  v_add_u32 v7, s19, v3
  s_waitcnt vmcnt(27)
  v_mfma_f32_16x16x32_bf16 v[16:19], v[112:115], v[96:99], v[16:19]
  v_mfma_f32_16x16x32_bf16 v[20:23], v[116:119], v[96:99], v[20:23]
  v_mfma_f32_16x16x32_bf16 v[24:27], v[120:123], v[96:99], v[24:27]
  v_mfma_f32_16x16x32_bf16 v[28:31], v[124:127], v[96:99], v[28:31]
  v_mfma_f32_16x16x32_bf16 v[32:35], v[128:131], v[96:99], v[32:35]
  v_mfma_f32_16x16x32_bf16 v[36:39], v[112:115], v[100:103], v[36:39]
  v_mfma_f32_16x16x32_bf16 v[40:43], v[116:119], v[100:103], v[40:43]
  v_mfma_f32_16x16x32_bf16 v[44:47], v[120:123], v[100:103], v[44:47]
  v_mfma_f32_16x16x32_bf16 v[48:51], v[124:127], v[100:103], v[48:51]
  v_mfma_f32_16x16x32_bf16 v[52:55], v[128:131], v[100:103], v[52:55]
  v_mfma_f32_16x16x32_bf16 v[56:59], v[112:115], v[104:107], v[56:59]
  v_mfma_f32_16x16x32_bf16 v[60:63], v[116:119], v[104:107], v[60:63]
  v_mfma_f32_16x16x32_bf16 v[64:67], v[120:123], v[104:107], v[64:67]
  v_mfma_f32_16x16x32_bf16 v[68:71], v[124:127], v[104:107], v[68:71]
  v_mfma_f32_16x16x32_bf16 v[72:75], v[128:131], v[104:107], v[72:75]
  v_mfma_f32_16x16x32_bf16 v[76:79], v[112:115], v[108:111], v[76:79]
  v_mfma_f32_16x16x32_bf16 v[80:83], v[116:119], v[108:111], v[80:83]
  v_mfma_f32_16x16x32_bf16 v[84:87], v[120:123], v[108:111], v[84:87]
  v_mfma_f32_16x16x32_bf16 v[88:91], v[124:127], v[108:111], v[88:91]
  v_mfma_f32_16x16x32_bf16 v[92:95], v[128:131], v[108:111], v[92:95]
  s_add_u32 s52, s44, s50
  buffer_load_dwordx4 v[112:115], v3, s[8:11], s52 offen
  s_add_u32 s53, s45, s50
  buffer_load_dwordx4 v[116:119], v3, s[8:11], s53 offen
  s_add_u32 s52, s46, s50
  buffer_load_dwordx4 v[120:123], v3, s[8:11], s52 offen
  s_add_u32 s53, s47, s50
  buffer_load_dwordx4 v[124:127], v3, s[8:11], s53 offen
  s_add_u32 s52, s48, s50
  buffer_load_dwordx4 v[128:131], v3, s[8:11], s52 offen
  s_add_u32 s52, s40, s50
  buffer_load_dwordx4 v[96:99], v3, s[8:11], s52 offen
  s_add_u32 s53, s41, s50
  buffer_load_dwordx4 v[100:103], v3, s[8:11], s53 offen
  s_add_u32 s52, s42, s50
  buffer_load_dwordx4 v[104:107], v3, s[8:11], s52 offen
  s_add_u32 s53, s43, s50
  buffer_load_dwordx4 v[108:111], v3, s[8:11], s53 offen
  s_add_u32 s50, s50, 1024
  s_cmp_eq_u32 s50, s51
  s_cselect_b32 s50, 0, s50
  s_waitcnt vmcnt(27)
  v_mfma_f32_16x16x32_bf16 v[16:19], v[148:151], v[132:135], v[16:19]
  v_mfma_f32_16x16x32_bf16 v[20:23], v[152:155], v[132:135], v[20:23]
  v_mfma_f32_16x16x32_bf16 v[24:27], v[156:159], v[132:135], v[24:27]
  v_mfma_f32_16x16x32_bf16 v[28:31], v[160:163], v[132:135], v[28:31]
  v_mfma_f32_16x16x32_bf16 v[32:35], v[164:167], v[132:135], v[32:35]
  v_mfma_f32_16x16x32_bf16 v[36:39], v[148:151], v[136:139], v[36:39]
  v_mfma_f32_16x16x32_bf16 v[40:43], v[152:155], v[136:139], v[40:43]
  v_mfma_f32_16x16x32_bf16 v[44:47], v[156:159], v[136:139], v[44:47]
  v_mfma_f32_16x16x32_bf16 v[48:51], v[160:163], v[136:139], v[48:51]
  v_mfma_f32_16x16x32_bf16 v[52:55], v[164:167], v[136:139], v[52:55]
  v_mfma_f32_16x16x32_bf16 v[56:59], v[148:151], v[140:143], v[56:59]
  v_mfma_f32_16x16x32_bf16 v[60:63], v[152:155], v[140:143], v[60:63]
  v_mfma_f32_16x16x32_bf16 v[64:67], v[156:159], v[140:143], v[64:67]
  v_mfma_f32_16x16x32_bf16 v[68:71], v[160:163], v[140:143], v[68:71]
  v_mfma_f32_16x16x32_bf16 v[72:75], v[164:167], v[140:143], v[72:75]
  v_mfma_f32_16x16x32_bf16 v[76:79], v[148:151], v[144:147], v[76:79]
  v_mfma_f32_16x16x32_bf16 v[80:83], v[152:155], v[144:147], v[80:83]
  v_mfma_f32_16x16x32_bf16 v[84:87], v[156:159], v[144:147], v[84:87]
  v_mfma_f32_16x16x32_bf16 v[88:91], v[160:163], v[144:147], v[88:91]
  v_mfma_f32_16x16x32_bf16 v[92:95], v[164:167], v[144:147], v[92:95]
  s_add_u32 s52, s44, s50
  buffer_load_dwordx4 v[148:151], v3, s[8:11], s52 offen
  s_add_u32 s53, s45, s50
  buffer_load_dwordx4 v[152:155], v3, s[8:11], s53 offen
  s_add_u32 s52, s46, s50
  buffer_load_dwordx4 v[156:159], v3, s[8:11], s52 offen
  s_add_u32 s53, s47, s50
  buffer_load_dwordx4 v[160:163], v3, s[8:11], s53 offen
  s_add_u32 s52, s48, s50
  buffer_load_dwordx4 v[164:167], v3, s[8:11], s52 offen
  s_add_u32 s52, s40, s50
  buffer_load_dwordx4 v[132:135], v3, s[8:11], s52 offen
  s_add_u32 s53, s41, s50
  buffer_load_dwordx4 v[136:139], v3, s[8:11], s53 offen
  s_add_u32 s52, s42, s50
  buffer_load_dwordx4 v[140:143], v3, s[8:11], s52 offen
  s_add_u32 s53, s43, s50
  buffer_load_dwordx4 v[144:147], v3, s[8:11], s53 offen
  s_add_u32 s50, s50, 1024
  s_cmp_eq_u32 s50, s51
  s_cselect_b32 s50, 0, s50
  s_waitcnt vmcnt(27)
  v_mfma_f32_16x16x32_bf16 v[16:19], v[184:187], v[168:171], v[16:19]
  v_mfma_f32_16x16x32_bf16 v[20:23], v[188:191], v[168:171], v[20:23]
  v_mfma_f32_16x16x32_bf16 v[24:27], v[192:195], v[168:171], v[24:27]
  v_mfma_f32_16x16x32_bf16 v[28:31], v[196:199], v[168:171], v[28:31]
  v_mfma_f32_16x16x32_bf16 v[32:35], v[200:203], v[168:171], v[32:35]
  v_mfma_f32_16x16x32_bf16 v[36:39], v[184:187], v[172:175], v[36:39]
  v_mfma_f32_16x16x32_bf16 v[40:43], v[188:191], v[172:175], v[40:43]
  v_mfma_f32_16x16x32_bf16 v[44:47], v[192:195], v[172:175], v[44:47]
  v_mfma_f32_16x16x32_bf16 v[48:51], v[196:199], v[172:175], v[48:51]
  v_mfma_f32_16x16x32_bf16 v[52:55], v[200:203], v[172:175], v[52:55]
  v_mfma_f32_16x16x32_bf16 v[56:59], v[184:187], v[176:179], v[56:59]
  v_mfma_f32_16x16x32_bf16 v[60:63], v[188:191], v[176:179], v[60:63]
  v_mfma_f32_16x16x32_bf16 v[64:67], v[192:195], v[176:179], v[64:67]
  v_mfma_f32_16x16x32_bf16 v[68:71], v[196:199], v[176:179], v[68:71]
  v_mfma_f32_16x16x32_bf16 v[72:75], v[200:203], v[176:179], v[72:75]
  v_mfma_f32_16x16x32_bf16 v[76:79], v[184:187], v[180:183], v[76:79]
  v_mfma_f32_16x16x32_bf16 v[80:83], v[188:191], v[180:183], v[80:83]
  v_mfma_f32_16x16x32_bf16 v[84:87], v[192:195], v[180:183], v[84:87]
  v_mfma_f32_16x16x32_bf16 v[88:91], v[196:199], v[180:183], v[88:91]
  v_mfma_f32_16x16x32_bf16 v[92:95], v[200:203], v[180:183], v[92:95]
  s_add_u32 s52, s44, s50
  buffer_load_dwordx4 v[184:187], v3, s[8:11], s52 offen
  s_add_u32 s53, s45, s50
  buffer_load_dwordx4 v[188:191], v3, s[8:11], s53 offen
  s_add_u32 s52, s46, s50
  buffer_load_dwordx4 v[192:195], v3, s[8:11], s52 offen
  s_add_u32 s53, s47, s50
  buffer_load_dwordx4 v[196:199], v3, s[8:11], s53 offen
  s_add_u32 s52, s48, s50
  buffer_load_dwordx4 v[200:203], v3, s[8:11], s52 offen
  s_add_u32 s52, s40, s50
  buffer_load_dwordx4 v[168:171], v3, s[8:11], s52 offen
  s_add_u32 s53, s41, s50
  buffer_load_dwordx4 v[172:175], v3, s[8:11], s53 offen
  s_add_u32 s52, s42, s50
  buffer_load_dwordx4 v[176:179], v3, s[8:11], s52 offen
  s_add_u32 s53, s43, s50
  buffer_load_dwordx4 v[180:183], v3, s[8:11], s53 offen
  s_add_u32 s50, s50, 1024
  s_cmp_eq_u32 s50, s51
  s_cselect_b32 s50, 0, s50
  v_and_b32 v8, 15, v1
  v_lshrrev_b32 v9, 4, v1
  s_lshl_b32 s19, s17, 6
  s_lshl_b32 s20, s32, 4
  s_add_u32 s19, s19, s20
  v_add_u32 v8, s19, v8
  v_mul_u32_u24 v8, 1280, v8
  s_mul_i32 s19, s16, 160
  v_add_u32 v8, s19, v8
  v_and_b32 v10, 1, v9
  v_lshlrev_b32 v10, 5, v10
  v_lshrrev_b32 v11, 1, v9
  v_lshl_add_u32 v10, v11, 4, v10
  v_add_u32 v10, v8, v10
  v_lshl_add_u32 v11, v9, 3, v8
  s_waitcnt vmcnt(27)
  v_mfma_f32_16x16x32_bf16 v[16:19], v[220:223], v[204:207], v[16:19]
  v_mfma_f32_16x16x32_bf16 v[20:23], v[224:227], v[204:207], v[20:23]
  v_mfma_f32_16x16x32_bf16 v[24:27], v[228:231], v[204:207], v[24:27]
  v_mfma_f32_16x16x32_bf16 v[28:31], v[232:235], v[204:207], v[28:31]
  v_mfma_f32_16x16x32_bf16 v[32:35], v[236:239], v[204:207], v[32:35]
  v_mfma_f32_16x16x32_bf16 v[36:39], v[220:223], v[208:211], v[36:39]
  v_mfma_f32_16x16x32_bf16 v[40:43], v[224:227], v[208:211], v[40:43]
  v_mfma_f32_16x16x32_bf16 v[44:47], v[228:231], v[208:211], v[44:47]
  v_mfma_f32_16x16x32_bf16 v[48:51], v[232:235], v[208:211], v[48:51]
  v_mfma_f32_16x16x32_bf16 v[52:55], v[236:239], v[208:211], v[52:55]
  v_mfma_f32_16x16x32_bf16 v[56:59], v[220:223], v[212:215], v[56:59]
  v_mfma_f32_16x16x32_bf16 v[60:63], v[224:227], v[212:215], v[60:63]
  v_mfma_f32_16x16x32_bf16 v[64:67], v[228:231], v[212:215], v[64:67]
  v_mfma_f32_16x16x32_bf16 v[68:71], v[232:235], v[212:215], v[68:71]
  v_mfma_f32_16x16x32_bf16 v[72:75], v[236:239], v[212:215], v[72:75]
  v_mfma_f32_16x16x32_bf16 v[76:79], v[220:223], v[216:219], v[76:79]
  v_mfma_f32_16x16x32_bf16 v[80:83], v[224:227], v[216:219], v[80:83]
  v_mfma_f32_16x16x32_bf16 v[84:87], v[228:231], v[216:219], v[84:87]
  v_mfma_f32_16x16x32_bf16 v[88:91], v[232:235], v[216:219], v[88:91]
  v_mfma_f32_16x16x32_bf16 v[92:95], v[236:239], v[216:219], v[92:95]
  s_add_u32 s52, s44, s50
  buffer_load_dwordx4 v[220:223], v3, s[8:11], s52 offen
  s_add_u32 s53, s45, s50
  buffer_load_dwordx4 v[224:227], v3, s[8:11], s53 offen
  s_add_u32 s52, s46, s50
  buffer_load_dwordx4 v[228:231], v3, s[8:11], s52 offen
  s_add_u32 s53, s47, s50
  buffer_load_dwordx4 v[232:235], v3, s[8:11], s53 offen
  s_add_u32 s52, s48, s50
  buffer_load_dwordx4 v[236:239], v3, s[8:11], s52 offen
  s_add_u32 s52, s40, s50
  buffer_load_dwordx4 v[204:207], v3, s[8:11], s52 offen
  s_add_u32 s53, s41, s50
  buffer_load_dwordx4 v[208:211], v3, s[8:11], s53 offen
  s_add_u32 s52, s42, s50
  buffer_load_dwordx4 v[212:215], v3, s[8:11], s52 offen
  s_add_u32 s53, s43, s50
  buffer_load_dwordx4 v[216:219], v3, s[8:11], s53 offen
  s_add_u32 s50, s50, 1024
  s_cmp_eq_u32 s50, s51
  s_cselect_b32 s50, 0, s50
  s_waitcnt vmcnt(27)
  v_mfma_f32_16x16x32_bf16 v[16:19], v[112:115], v[96:99], v[16:19]
  v_mfma_f32_16x16x32_bf16 v[20:23], v[116:119], v[96:99], v[20:23]
  v_mfma_f32_16x16x32_bf16 v[24:27], v[120:123], v[96:99], v[24:27]
  v_mfma_f32_16x16x32_bf16 v[28:31], v[124:127], v[96:99], v[28:31]
  v_mfma_f32_16x16x32_bf16 v[32:35], v[128:131], v[96:99], v[32:35]
  v_mfma_f32_16x16x32_bf16 v[36:39], v[112:115], v[100:103], v[36:39]
  v_mfma_f32_16x16x32_bf16 v[40:43], v[116:119], v[100:103], v[40:43]
  v_mfma_f32_16x16x32_bf16 v[44:47], v[120:123], v[100:103], v[44:47]
  v_mfma_f32_16x16x32_bf16 v[48:51], v[124:127], v[100:103], v[48:51]
  v_mfma_f32_16x16x32_bf16 v[52:55], v[128:131], v[100:103], v[52:55]
  v_mfma_f32_16x16x32_bf16 v[56:59], v[112:115], v[104:107], v[56:59]
  v_mfma_f32_16x16x32_bf16 v[60:63], v[116:119], v[104:107], v[60:63]
  v_mfma_f32_16x16x32_bf16 v[64:67], v[120:123], v[104:107], v[64:67]
  v_mfma_f32_16x16x32_bf16 v[68:71], v[124:127], v[104:107], v[68:71]
  v_mfma_f32_16x16x32_bf16 v[72:75], v[128:131], v[104:107], v[72:75]
  v_mfma_f32_16x16x32_bf16 v[76:79], v[112:115], v[108:111], v[76:79]
  v_mfma_f32_16x16x32_bf16 v[80:83], v[116:119], v[108:111], v[80:83]
  v_mfma_f32_16x16x32_bf16 v[84:87], v[120:123], v[108:111], v[84:87]
  v_mfma_f32_16x16x32_bf16 v[88:91], v[124:127], v[108:111], v[88:91]
  v_mfma_f32_16x16x32_bf16 v[92:95], v[128:131], v[108:111], v[92:95]
  s_add_u32 s52, s44, s50
  buffer_load_dwordx4 v[112:115], v3, s[8:11], s52 offen
  s_add_u32 s53, s45, s50
  buffer_load_dwordx4 v[116:119], v3, s[8:11], s53 offen
  s_add_u32 s52, s46, s50
  buffer_load_dwordx4 v[120:123], v3, s[8:11], s52 offen
  s_add_u32 s53, s47, s50
  buffer_load_dwordx4 v[124:127], v3, s[8:11], s53 offen
  s_add_u32 s52, s48, s50
  buffer_load_dwordx4 v[128:131], v3, s[8:11], s52 offen
  s_add_u32 s52, s40, s50
  buffer_load_dwordx4 v[96:99], v3, s[8:11], s52 offen
  s_add_u32 s53, s41, s50
  buffer_load_dwordx4 v[100:103], v3, s[8:11], s53 offen
  s_add_u32 s52, s42, s50
  buffer_load_dwordx4 v[104:107], v3, s[8:11], s52 offen
  s_add_u32 s53, s43, s50
  buffer_load_dwordx4 v[108:111], v3, s[8:11], s53 offen
  s_add_u32 s50, s50, 1024
  s_cmp_eq_u32 s50, s51
  s_cselect_b32 s50, 0, s50
  s_waitcnt vmcnt(27)
  v_mfma_f32_16x16x32_bf16 v[16:19], v[148:151], v[132:135], v[16:19]
  v_mfma_f32_16x16x32_bf16 v[20:23], v[152:155], v[132:135], v[20:23]
  v_mfma_f32_16x16x32_bf16 v[24:27], v[156:159], v[132:135], v[24:27]
  v_mfma_f32_16x16x32_bf16 v[28:31], v[160:163], v[132:135], v[28:31]
  v_mfma_f32_16x16x32_bf16 v[32:35], v[164:167], v[132:135], v[32:35]
  v_mfma_f32_16x16x32_bf16 v[36:39], v[148:151], v[136:139], v[36:39]
  v_mfma_f32_16x16x32_bf16 v[40:43], v[152:155], v[136:139], v[40:43]
  v_mfma_f32_16x16x32_bf16 v[44:47], v[156:159], v[136:139], v[44:47]
  v_mfma_f32_16x16x32_bf16 v[48:51], v[160:163], v[136:139], v[48:51]
  v_mfma_f32_16x16x32_bf16 v[52:55], v[164:167], v[136:139], v[52:55]
  v_mfma_f32_16x16x32_bf16 v[56:59], v[148:151], v[140:143], v[56:59]
  v_mfma_f32_16x16x32_bf16 v[60:63], v[152:155], v[140:143], v[60:63]
  v_mfma_f32_16x16x32_bf16 v[64:67], v[156:159], v[140:143], v[64:67]
  v_mfma_f32_16x16x32_bf16 v[68:71], v[160:163], v[140:143], v[68:71]
  v_mfma_f32_16x16x32_bf16 v[72:75], v[164:167], v[140:143], v[72:75]
  v_mfma_f32_16x16x32_bf16 v[76:79], v[148:151], v[144:147], v[76:79]
  v_mfma_f32_16x16x32_bf16 v[80:83], v[152:155], v[144:147], v[80:83]
  v_mfma_f32_16x16x32_bf16 v[84:87], v[156:159], v[144:147], v[84:87]
  v_mfma_f32_16x16x32_bf16 v[88:91], v[160:163], v[144:147], v[88:91]
  v_mfma_f32_16x16x32_bf16 v[92:95], v[164:167], v[144:147], v[92:95]
  s_add_u32 s52, s44, s50
  buffer_load_dwordx4 v[148:151], v3, s[8:11], s52 offen
  s_add_u32 s53, s45, s50
  buffer_load_dwordx4 v[152:155], v3, s[8:11], s53 offen
  s_add_u32 s52, s46, s50
  buffer_load_dwordx4 v[156:159], v3, s[8:11], s52 offen
  s_add_u32 s53, s47, s50
  buffer_load_dwordx4 v[160:163], v3, s[8:11], s53 offen
  s_add_u32 s52, s48, s50
  buffer_load_dwordx4 v[164:167], v3, s[8:11], s52 offen
  s_add_u32 s52, s40, s50
  buffer_load_dwordx4 v[132:135], v3, s[8:11], s52 offen
  s_add_u32 s53, s41, s50
  buffer_load_dwordx4 v[136:139], v3, s[8:11], s53 offen
  s_add_u32 s52, s42, s50
  buffer_load_dwordx4 v[140:143], v3, s[8:11], s52 offen
  s_add_u32 s53, s43, s50
  buffer_load_dwordx4 v[144:147], v3, s[8:11], s53 offen
  s_add_u32 s50, s50, 1024
  s_cmp_eq_u32 s50, s51
  s_cselect_b32 s50, 0, s50
  s_waitcnt vmcnt(27)
  v_mfma_f32_16x16x32_bf16 v[16:19], v[184:187], v[168:171], v[16:19]
  v_mfma_f32_16x16x32_bf16 v[20:23], v[188:191], v[168:171], v[20:23]
  v_mfma_f32_16x16x32_bf16 v[24:27], v[192:195], v[168:171], v[24:27]
  v_mfma_f32_16x16x32_bf16 v[28:31], v[196:199], v[168:171], v[28:31]
  v_mfma_f32_16x16x32_bf16 v[32:35], v[200:203], v[168:171], v[32:35]
  v_mfma_f32_16x16x32_bf16 v[36:39], v[184:187], v[172:175], v[36:39]
  v_mfma_f32_16x16x32_bf16 v[40:43], v[188:191], v[172:175], v[40:43]
  v_mfma_f32_16x16x32_bf16 v[44:47], v[192:195], v[172:175], v[44:47]
  v_mfma_f32_16x16x32_bf16 v[48:51], v[196:199], v[172:175], v[48:51]
  v_mfma_f32_16x16x32_bf16 v[52:55], v[200:203], v[172:175], v[52:55]
  v_mfma_f32_16x16x32_bf16 v[56:59], v[184:187], v[176:179], v[56:59]
  v_mfma_f32_16x16x32_bf16 v[60:63], v[188:191], v[176:179], v[60:63]
  v_mfma_f32_16x16x32_bf16 v[64:67], v[192:195], v[176:179], v[64:67]
  v_mfma_f32_16x16x32_bf16 v[68:71], v[196:199], v[176:179], v[68:71]
  v_mfma_f32_16x16x32_bf16 v[72:75], v[200:203], v[176:179], v[72:75]
  v_mfma_f32_16x16x32_bf16 v[76:79], v[184:187], v[180:183], v[76:79]
  v_mfma_f32_16x16x32_bf16 v[80:83], v[188:191], v[180:183], v[80:83]
  v_mfma_f32_16x16x32_bf16 v[84:87], v[192:195], v[180:183], v[84:87]
  v_mfma_f32_16x16x32_bf16 v[88:91], v[196:199], v[180:183], v[88:91]
  v_mfma_f32_16x16x32_bf16 v[92:95], v[200:203], v[180:183], v[92:95]
  s_add_u32 s52, s44, s50
  buffer_load_dwordx4 v[184:187], v3, s[8:11], s52 offen
  s_add_u32 s53, s45, s50
  buffer_load_dwordx4 v[188:191], v3, s[8:11], s53 offen
  s_add_u32 s52, s46, s50
  buffer_load_dwordx4 v[192:195], v3, s[8:11], s52 offen
  s_add_u32 s53, s47, s50
  buffer_load_dwordx4 v[196:199], v3, s[8:11], s53 offen
  s_add_u32 s52, s48, s50
  buffer_load_dwordx4 v[200:203], v3, s[8:11], s52 offen
  s_add_u32 s52, s40, s50
  buffer_load_dwordx4 v[168:171], v3, s[8:11], s52 offen
  s_add_u32 s53, s41, s50
  buffer_load_dwordx4 v[172:175], v3, s[8:11], s53 offen
  s_add_u32 s52, s42, s50
  buffer_load_dwordx4 v[176:179], v3, s[8:11], s52 offen
  s_add_u32 s53, s43, s50
  buffer_load_dwordx4 v[180:183], v3, s[8:11], s53 offen
  s_add_u32 s50, s50, 1024
  s_cmp_eq_u32 s50, s51
  s_cselect_b32 s50, 0, s50
  s_waitcnt vmcnt(27)
  v_mfma_f32_16x16x32_bf16 v[16:19], v[220:223], v[204:207], v[16:19]
  v_mfma_f32_16x16x32_bf16 v[20:23], v[224:227], v[204:207], v[20:23]
  v_mfma_f32_16x16x32_bf16 v[24:27], v[228:231], v[204:207], v[24:27]
  v_mfma_f32_16x16x32_bf16 v[28:31], v[232:235], v[204:207], v[28:31]
  v_mfma_f32_16x16x32_bf16 v[32:35], v[236:239], v[204:207], v[32:35]
  v_mfma_f32_16x16x32_bf16 v[36:39], v[220:223], v[208:211], v[36:39]
  v_mfma_f32_16x16x32_bf16 v[40:43], v[224:227], v[208:211], v[40:43]
  v_mfma_f32_16x16x32_bf16 v[44:47], v[228:231], v[208:211], v[44:47]
  v_mfma_f32_16x16x32_bf16 v[48:51], v[232:235], v[208:211], v[48:51]
  v_mfma_f32_16x16x32_bf16 v[52:55], v[236:239], v[208:211], v[52:55]
  v_mfma_f32_16x16x32_bf16 v[56:59], v[220:223], v[212:215], v[56:59]
  v_mfma_f32_16x16x32_bf16 v[60:63], v[224:227], v[212:215], v[60:63]
  v_mfma_f32_16x16x32_bf16 v[64:67], v[228:231], v[212:215], v[64:67]
  v_mfma_f32_16x16x32_bf16 v[68:71], v[232:235], v[212:215], v[68:71]
  v_mfma_f32_16x16x32_bf16 v[72:75], v[236:239], v[212:215], v[72:75]
  v_mfma_f32_16x16x32_bf16 v[76:79], v[220:223], v[216:219], v[76:79]
  v_mfma_f32_16x16x32_bf16 v[80:83], v[224:227], v[216:219], v[80:83]
  v_mfma_f32_16x16x32_bf16 v[84:87], v[228:231], v[216:219], v[84:87]
  v_mfma_f32_16x16x32_bf16 v[88:91], v[232:235], v[216:219], v[88:91]
  v_mfma_f32_16x16x32_bf16 v[92:95], v[236:239], v[216:219], v[92:95]
  s_add_u32 s52, s44, s50
  buffer_load_dwordx4 v[220:223], v3, s[8:11], s52 offen
  s_add_u32 s53, s45, s50
  buffer_load_dwordx4 v[224:227], v3, s[8:11], s53 offen
  s_add_u32 s52, s46, s50
  buffer_load_dwordx4 v[228:231], v3, s[8:11], s52 offen
  s_add_u32 s53, s47, s50
  buffer_load_dwordx4 v[232:235], v3, s[8:11], s53 offen
  s_add_u32 s52, s48, s50
  buffer_load_dwordx4 v[236:239], v3, s[8:11], s52 offen
  s_add_u32 s52, s40, s50
  buffer_load_dwordx4 v[204:207], v3, s[8:11], s52 offen
  s_add_u32 s53, s41, s50
  buffer_load_dwordx4 v[208:211], v3, s[8:11], s53 offen
  s_add_u32 s52, s42, s50
  buffer_load_dwordx4 v[212:215], v3, s[8:11], s52 offen
  s_add_u32 s53, s43, s50
  buffer_load_dwordx4 v[216:219], v3, s[8:11], s53 offen
  s_add_u32 s50, s50, 1024
  s_cmp_eq_u32 s50, s51
  s_cselect_b32 s50, 0, s50
  s_waitcnt vmcnt(27)
  v_mfma_f32_16x16x32_bf16 v[16:19], v[112:115], v[96:99], v[16:19]
  v_mfma_f32_16x16x32_bf16 v[20:23], v[116:119], v[96:99], v[20:23]
  v_mfma_f32_16x16x32_bf16 v[24:27], v[120:123], v[96:99], v[24:27]
  v_mfma_f32_16x16x32_bf16 v[28:31], v[124:127], v[96:99], v[28:31]
  v_mfma_f32_16x16x32_bf16 v[32:35], v[128:131], v[96:99], v[32:35]
  v_mfma_f32_16x16x32_bf16 v[36:39], v[112:115], v[100:103], v[36:39]
  v_mfma_f32_16x16x32_bf16 v[40:43], v[116:119], v[100:103], v[40:43]
  v_mfma_f32_16x16x32_bf16 v[44:47], v[120:123], v[100:103], v[44:47]
  v_mfma_f32_16x16x32_bf16 v[48:51], v[124:127], v[100:103], v[48:51]
  v_mfma_f32_16x16x32_bf16 v[52:55], v[128:131], v[100:103], v[52:55]
  v_mfma_f32_16x16x32_bf16 v[56:59], v[112:115], v[104:107], v[56:59]
  v_mfma_f32_16x16x32_bf16 v[60:63], v[116:119], v[104:107], v[60:63]
  v_mfma_f32_16x16x32_bf16 v[64:67], v[120:123], v[104:107], v[64:67]
  v_mfma_f32_16x16x32_bf16 v[68:71], v[124:127], v[104:107], v[68:71]
  v_mfma_f32_16x16x32_bf16 v[72:75], v[128:131], v[104:107], v[72:75]
  v_mfma_f32_16x16x32_bf16 v[76:79], v[112:115], v[108:111], v[76:79]
  v_mfma_f32_16x16x32_bf16 v[80:83], v[116:119], v[108:111], v[80:83]
  v_mfma_f32_16x16x32_bf16 v[84:87], v[120:123], v[108:111], v[84:87]
  v_mfma_f32_16x16x32_bf16 v[88:91], v[124:127], v[108:111], v[88:91]
  v_mfma_f32_16x16x32_bf16 v[92:95], v[128:131], v[108:111], v[92:95]
  s_add_u32 s52, s44, s50
  buffer_load_dwordx4 v[112:115], v3, s[8:11], s52 offen
  s_add_u32 s53, s45, s50
  buffer_load_dwordx4 v[116:119], v3, s[8:11], s53 offen
  s_add_u32 s52, s46, s50
  buffer_load_dwordx4 v[120:123], v3, s[8:11], s52 offen
  s_add_u32 s53, s47, s50
  buffer_load_dwordx4 v[124:127], v3, s[8:11], s53 offen
  s_add_u32 s52, s48, s50
  buffer_load_dwordx4 v[128:131], v3, s[8:11], s52 offen
  s_add_u32 s52, s40, s50
  buffer_load_dwordx4 v[96:99], v3, s[8:11], s52 offen
  s_add_u32 s53, s41, s50
  buffer_load_dwordx4 v[100:103], v3, s[8:11], s53 offen
  s_add_u32 s52, s42, s50
  buffer_load_dwordx4 v[104:107], v3, s[8:11], s52 offen
  s_add_u32 s53, s43, s50
  buffer_load_dwordx4 v[108:111], v3, s[8:11], s53 offen
  s_add_u32 s50, s50, 1024
  s_cmp_eq_u32 s50, s51
  s_cselect_b32 s50, 0, s50
  s_waitcnt vmcnt(27)
  v_mfma_f32_16x16x32_bf16 v[16:19], v[148:151], v[132:135], v[16:19]
  v_mfma_f32_16x16x32_bf16 v[20:23], v[152:155], v[132:135], v[20:23]
  v_mfma_f32_16x16x32_bf16 v[24:27], v[156:159], v[132:135], v[24:27]
  v_mfma_f32_16x16x32_bf16 v[28:31], v[160:163], v[132:135], v[28:31]
  v_mfma_f32_16x16x32_bf16 v[32:35], v[164:167], v[132:135], v[32:35]
  v_mfma_f32_16x16x32_bf16 v[36:39], v[148:151], v[136:139], v[36:39]
  v_mfma_f32_16x16x32_bf16 v[40:43], v[152:155], v[136:139], v[40:43]
  v_mfma_f32_16x16x32_bf16 v[44:47], v[156:159], v[136:139], v[44:47]
  v_mfma_f32_16x16x32_bf16 v[48:51], v[160:163], v[136:139], v[48:51]
  v_mfma_f32_16x16x32_bf16 v[52:55], v[164:167], v[136:139], v[52:55]
  v_mfma_f32_16x16x32_bf16 v[56:59], v[148:151], v[140:143], v[56:59]
  v_mfma_f32_16x16x32_bf16 v[60:63], v[152:155], v[140:143], v[60:63]
  v_mfma_f32_16x16x32_bf16 v[64:67], v[156:159], v[140:143], v[64:67]
  v_mfma_f32_16x16x32_bf16 v[68:71], v[160:163], v[140:143], v[68:71]
  v_mfma_f32_16x16x32_bf16 v[72:75], v[164:167], v[140:143], v[72:75]
  v_mfma_f32_16x16x32_bf16 v[76:79], v[148:151], v[144:147], v[76:79]
  v_mfma_f32_16x16x32_bf16 v[80:83], v[152:155], v[144:147], v[80:83]
  v_mfma_f32_16x16x32_bf16 v[84:87], v[156:159], v[144:147], v[84:87]
  v_mfma_f32_16x16x32_bf16 v[88:91], v[160:163], v[144:147], v[88:91]
  v_mfma_f32_16x16x32_bf16 v[92:95], v[164:167], v[144:147], v[92:95]
  s_cmp_lt_u32 s32, 2
  s_cselect_b32 s50, s50, 0x40000000
  s_add_u32 s52, s44, s50
  buffer_load_dwordx4 v[148:151], v3, s[8:11], s52 offen
  s_add_u32 s53, s45, s50
  buffer_load_dwordx4 v[152:155], v3, s[8:11], s53 offen
  s_add_u32 s52, s46, s50
  buffer_load_dwordx4 v[156:159], v3, s[8:11], s52 offen
  s_add_u32 s53, s47, s50
  buffer_load_dwordx4 v[160:163], v3, s[8:11], s53 offen
  s_add_u32 s52, s48, s50
  buffer_load_dwordx4 v[164:167], v3, s[8:11], s52 offen
  s_add_u32 s52, s40, s50
  buffer_load_dwordx4 v[132:135], v3, s[8:11], s52 offen
  s_add_u32 s53, s41, s50
  buffer_load_dwordx4 v[136:139], v3, s[8:11], s53 offen
  s_add_u32 s52, s42, s50
  buffer_load_dwordx4 v[140:143], v3, s[8:11], s52 offen
  s_add_u32 s53, s43, s50
  buffer_load_dwordx4 v[144:147], v3, s[8:11], s53 offen
  s_add_u32 s50, s50, 1024
  s_cmp_eq_u32 s50, s51
  s_cselect_b32 s50, 0, s50
  s_waitcnt vmcnt(27)
  v_mfma_f32_16x16x32_bf16 v[16:19], v[184:187], v[168:171], v[16:19]
  v_mfma_f32_16x16x32_bf16 v[20:23], v[188:191], v[168:171], v[20:23]
  v_mfma_f32_16x16x32_bf16 v[24:27], v[192:195], v[168:171], v[24:27]
  v_mfma_f32_16x16x32_bf16 v[28:31], v[196:199], v[168:171], v[28:31]
  v_mfma_f32_16x16x32_bf16 v[32:35], v[200:203], v[168:171], v[32:35]
  v_mfma_f32_16x16x32_bf16 v[36:39], v[184:187], v[172:175], v[36:39]
  v_mfma_f32_16x16x32_bf16 v[40:43], v[188:191], v[172:175], v[40:43]
  v_mfma_f32_16x16x32_bf16 v[44:47], v[192:195], v[172:175], v[44:47]
  v_mfma_f32_16x16x32_bf16 v[48:51], v[196:199], v[172:175], v[48:51]
  v_mfma_f32_16x16x32_bf16 v[52:55], v[200:203], v[172:175], v[52:55]
  v_mfma_f32_16x16x32_bf16 v[56:59], v[184:187], v[176:179], v[56:59]
  v_mfma_f32_16x16x32_bf16 v[60:63], v[188:191], v[176:179], v[60:63]
  v_mfma_f32_16x16x32_bf16 v[64:67], v[192:195], v[176:179], v[64:67]
  v_mfma_f32_16x16x32_bf16 v[68:71], v[196:199], v[176:179], v[68:71]
  v_mfma_f32_16x16x32_bf16 v[72:75], v[200:203], v[176:179], v[72:75]
  v_mfma_f32_16x16x32_bf16 v[76:79], v[184:187], v[180:183], v[76:79]
  v_mfma_f32_16x16x32_bf16 v[80:83], v[188:191], v[180:183], v[80:83]
  v_mfma_f32_16x16x32_bf16 v[84:87], v[192:195], v[180:183], v[84:87]
  v_mfma_f32_16x16x32_bf16 v[88:91], v[196:199], v[180:183], v[88:91]
  v_mfma_f32_16x16x32_bf16 v[92:95], v[200:203], v[180:183], v[92:95]
  s_waitcnt vmcnt(18)
  v_mfma_f32_16x16x32_bf16 v[16:19], v[220:223], v[204:207], v[16:19]
  v_mfma_f32_16x16x32_bf16 v[20:23], v[224:227], v[204:207], v[20:23]
  v_mfma_f32_16x16x32_bf16 v[24:27], v[228:231], v[204:207], v[24:27]
  v_mfma_f32_16x16x32_bf16 v[28:31], v[232:235], v[204:207], v[28:31]
  v_mfma_f32_16x16x32_bf16 v[32:35], v[236:239], v[204:207], v[32:35]
  v_mfma_f32_16x16x32_bf16 v[36:39], v[220:223], v[208:211], v[36:39]
  v_mfma_f32_16x16x32_bf16 v[40:43], v[224:227], v[208:211], v[40:43]
  v_mfma_f32_16x16x32_bf16 v[44:47], v[228:231], v[208:211], v[44:47]
  v_mfma_f32_16x16x32_bf16 v[48:51], v[232:235], v[208:211], v[48:51]
  v_mfma_f32_16x16x32_bf16 v[52:55], v[236:239], v[208:211], v[52:55]
  v_mfma_f32_16x16x32_bf16 v[56:59], v[220:223], v[212:215], v[56:59]
  v_mfma_f32_16x16x32_bf16 v[60:63], v[224:227], v[212:215], v[60:63]
  v_mfma_f32_16x16x32_bf16 v[64:67], v[228:231], v[212:215], v[64:67]
  v_mfma_f32_16x16x32_bf16 v[68:71], v[232:235], v[212:215], v[68:71]
  v_mfma_f32_16x16x32_bf16 v[72:75], v[236:239], v[212:215], v[72:75]
  v_mfma_f32_16x16x32_bf16 v[76:79], v[220:223], v[216:219], v[76:79]
  v_mfma_f32_16x16x32_bf16 v[80:83], v[224:227], v[216:219], v[80:83]
  v_mfma_f32_16x16x32_bf16 v[84:87], v[228:231], v[216:219], v[84:87]
  v_mfma_f32_16x16x32_bf16 v[88:91], v[232:235], v[216:219], v[88:91]
  v_mfma_f32_16x16x32_bf16 v[92:95], v[236:239], v[216:219], v[92:95]
  s_waitcnt vmcnt(9)
  v_mfma_f32_16x16x32_bf16 v[16:19], v[112:115], v[96:99], v[16:19]
  v_mfma_f32_16x16x32_bf16 v[20:23], v[116:119], v[96:99], v[20:23]
  v_mfma_f32_16x16x32_bf16 v[24:27], v[120:123], v[96:99], v[24:27]
  v_mfma_f32_16x16x32_bf16 v[28:31], v[124:127], v[96:99], v[28:31]
  v_mfma_f32_16x16x32_bf16 v[32:35], v[128:131], v[96:99], v[32:35]
  v_mfma_f32_16x16x32_bf16 v[36:39], v[112:115], v[100:103], v[36:39]
  v_mfma_f32_16x16x32_bf16 v[40:43], v[116:119], v[100:103], v[40:43]
  v_mfma_f32_16x16x32_bf16 v[44:47], v[120:123], v[100:103], v[44:47]
  v_mfma_f32_16x16x32_bf16 v[48:51], v[124:127], v[100:103], v[48:51]
  v_mfma_f32_16x16x32_bf16 v[52:55], v[128:131], v[100:103], v[52:55]
  v_mfma_f32_16x16x32_bf16 v[56:59], v[112:115], v[104:107], v[56:59]
  v_mfma_f32_16x16x32_bf16 v[60:63], v[116:119], v[104:107], v[60:63]
  v_mfma_f32_16x16x32_bf16 v[64:67], v[120:123], v[104:107], v[64:67]
  v_mfma_f32_16x16x32_bf16 v[68:71], v[124:127], v[104:107], v[68:71]
  v_mfma_f32_16x16x32_bf16 v[72:75], v[128:131], v[104:107], v[72:75]
  v_mfma_f32_16x16x32_bf16 v[76:79], v[112:115], v[108:111], v[76:79]
  v_mfma_f32_16x16x32_bf16 v[80:83], v[116:119], v[108:111], v[80:83]
  v_mfma_f32_16x16x32_bf16 v[84:87], v[120:123], v[108:111], v[84:87]
  v_mfma_f32_16x16x32_bf16 v[88:91], v[124:127], v[108:111], v[88:91]
  v_mfma_f32_16x16x32_bf16 v[92:95], v[128:131], v[108:111], v[92:95]
  s_waitcnt vmcnt(0)
  v_mfma_f32_16x16x32_bf16 v[36:39], v[148:151], v[136:139], v[36:39]
  v_mfma_f32_16x16x32_bf16 v[40:43], v[152:155], v[136:139], v[40:43]
  v_mfma_f32_16x16x32_bf16 v[44:47], v[156:159], v[136:139], v[44:47]
  v_mfma_f32_16x16x32_bf16 v[48:51], v[160:163], v[136:139], v[48:51]
  v_mfma_f32_16x16x32_bf16 v[52:55], v[164:167], v[136:139], v[52:55]
  v_mfma_f32_16x16x32_bf16 v[56:59], v[148:151], v[140:143], v[56:59]
  v_mfma_f32_16x16x32_bf16 v[60:63], v[152:155], v[140:143], v[60:63]
  v_mfma_f32_16x16x32_bf16 v[64:67], v[156:159], v[140:143], v[64:67]
  v_mfma_f32_16x16x32_bf16 v[68:71], v[160:163], v[140:143], v[68:71]
  v_mfma_f32_16x16x32_bf16 v[72:75], v[164:167], v[140:143], v[72:75]
  v_mfma_f32_16x16x32_bf16 v[76:79], v[148:151], v[144:147], v[76:79]
  ds_write_b128 v4, v[36:39] offset:0
  v_mfma_f32_16x16x32_bf16 v[80:83], v[152:155], v[144:147], v[80:83]
  ds_write_b128 v4, v[40:43] offset:1024
  v_mfma_f32_16x16x32_bf16 v[84:87], v[156:159], v[144:147], v[84:87]
  ds_write_b128 v4, v[44:47] offset:2048
  v_mfma_f32_16x16x32_bf16 v[88:91], v[160:163], v[144:147], v[88:91]
  ds_write_b128 v4, v[48:51] offset:3072
  v_mfma_f32_16x16x32_bf16 v[92:95], v[164:167], v[144:147], v[92:95]
  ds_write_b128 v4, v[52:55] offset:4096
  v_mfma_f32_16x16x32_bf16 v[16:19], v[148:151], v[132:135], v[16:19]
  ds_write_b128 v5, v[56:59] offset:0
  v_mfma_f32_16x16x32_bf16 v[20:23], v[152:155], v[132:135], v[20:23]
  ds_write_b128 v5, v[60:63] offset:1024
  v_mfma_f32_16x16x32_bf16 v[24:27], v[156:159], v[132:135], v[24:27]
  ds_write_b128 v5, v[64:67] offset:2048
  v_mfma_f32_16x16x32_bf16 v[28:31], v[160:163], v[132:135], v[28:31]
  ds_write_b128 v5, v[68:71] offset:3072
  v_mfma_f32_16x16x32_bf16 v[32:35], v[164:167], v[132:135], v[32:35]
  ds_write_b128 v5, v[72:75] offset:4096
  s_nop 4
  ds_write_b128 v6, v[76:79] offset:0
  ds_write_b128 v6, v[80:83] offset:1024
  ds_write_b128 v6, v[84:87] offset:2048
  ds_write_b128 v6, v[88:91] offset:3072
  ds_write_b128 v6, v[92:95] offset:4096
  s_waitcnt lgkmcnt(0)
  s_barrier
  ds_read_b128 v[96:99], v7 offset:0
  ds_read_b128 v[116:119], v7 offset:5120
  ds_read_b128 v[136:139], v7 offset:10240
  ds_read_b128 v[100:103], v7 offset:1024
  ds_read_b128 v[120:123], v7 offset:6144
  ds_read_b128 v[140:143], v7 offset:11264
  ds_read_b128 v[104:107], v7 offset:2048
  ds_read_b128 v[124:127], v7 offset:7168
  ds_read_b128 v[144:147], v7 offset:12288
  ds_read_b128 v[108:111], v7 offset:3072
  ds_read_b128 v[128:131], v7 offset:8192
  ds_read_b128 v[148:151], v7 offset:13312
  ds_read_b128 v[112:115], v7 offset:4096
  ds_read_b128 v[132:135], v7 offset:9216
  ds_read_b128 v[152:155], v7 offset:14336
  s_waitcnt lgkmcnt(12)
  v_pk_add_f32 v[16:17], v[16:17], v[96:97]
  v_pk_add_f32 v[116:117], v[116:117], v[136:137]
  v_pk_add_f32 v[18:19], v[18:19], v[98:99]
  v_pk_add_f32 v[118:119], v[118:119], v[138:139]
  v_pk_add_f32 v[16:17], v[16:17], v[116:117]
  v_pk_add_f32 v[18:19], v[18:19], v[118:119]
  s_waitcnt lgkmcnt(9)
  v_pk_add_f32 v[20:21], v[20:21], v[100:101]
  v_pk_add_f32 v[120:121], v[120:121], v[140:141]
  v_pk_add_f32 v[22:23], v[22:23], v[102:103]
  v_pk_add_f32 v[122:123], v[122:123], v[142:143]
  v_pk_add_f32 v[20:21], v[20:21], v[120:121]
  v_pk_add_f32 v[22:23], v[22:23], v[122:123]
  s_waitcnt lgkmcnt(6)
  v_pk_add_f32 v[24:25], v[24:25], v[104:105]
  v_pk_add_f32 v[124:125], v[124:125], v[144:145]
  v_pk_add_f32 v[26:27], v[26:27], v[106:107]
  v_pk_add_f32 v[126:127], v[126:127], v[146:147]
  v_pk_add_f32 v[24:25], v[24:25], v[124:125]
  v_pk_add_f32 v[26:27], v[26:27], v[126:127]
  s_waitcnt lgkmcnt(3)
  v_pk_add_f32 v[28:29], v[28:29], v[108:109]
  v_pk_add_f32 v[128:129], v[128:129], v[148:149]
  v_pk_add_f32 v[30:31], v[30:31], v[110:111]
  v_pk_add_f32 v[130:131], v[130:131], v[150:151]
  v_pk_add_f32 v[28:29], v[28:29], v[128:129]
  v_pk_add_f32 v[30:31], v[30:31], v[130:131]
  s_waitcnt lgkmcnt(0)
  v_pk_add_f32 v[32:33], v[32:33], v[112:113]
  v_pk_add_f32 v[132:133], v[132:133], v[152:153]
  v_pk_add_f32 v[34:35], v[34:35], v[114:115]
  v_pk_add_f32 v[134:135], v[134:135], v[154:155]
  v_pk_add_f32 v[32:33], v[32:33], v[132:133]
  v_pk_add_f32 v[34:35], v[34:35], v[134:135]
  v_cvt_pk_bf16_f32 v200, v16, v17
  v_cvt_pk_bf16_f32 v201, v18, v19
  v_cvt_pk_bf16_f32 v202, v20, v21
  v_cvt_pk_bf16_f32 v203, v22, v23
  v_cvt_pk_bf16_f32 v204, v24, v25
  v_cvt_pk_bf16_f32 v205, v26, v27
  v_cvt_pk_bf16_f32 v206, v28, v29
  v_cvt_pk_bf16_f32 v207, v30, v31
  v_cvt_pk_bf16_f32 v208, v32, v33
  v_cvt_pk_bf16_f32 v209, v34, v35
  s_nop 1
  v_permlane16_swap_b32 v200, v202
  v_permlane16_swap_b32 v201, v203
  v_permlane16_swap_b32 v204, v206
  v_permlane16_swap_b32 v205, v207
  s_nop 1
  buffer_store_dwordx4 v[200:203], v10, s[24:27], 0 offen offset:0
  buffer_store_dwordx4 v[204:207], v10, s[24:27], 0 offen offset:64
  buffer_store_dwordx2 v[208:209], v11, s[24:27], 0 offen offset:128
L2_end:
  s_endpgm
.section .rodata,"a"
.p2align 6
.amdhsa_kernel standalone__geglu_ffn__prompt_k1_kernel
  .amdhsa_next_free_vgpr 168
  .amdhsa_next_free_sgpr 102
  .amdhsa_accum_offset 168
  .amdhsa_group_segment_fixed_size 0
  .amdhsa_kernarg_size 56
  .amdhsa_user_sgpr_count 2
  .amdhsa_user_sgpr_kernarg_segment_ptr 1
  .amdhsa_system_sgpr_workgroup_id_x 1
  .amdhsa_float_denorm_mode_32 3
.end_amdhsa_kernel

.p2align 6
.amdhsa_kernel standalone__geglu_ffn__prompt_k2_kernel
  .amdhsa_next_free_vgpr 240
  .amdhsa_next_free_sgpr 102
  .amdhsa_accum_offset 240
  .amdhsa_group_segment_fixed_size 0
  .amdhsa_kernarg_size 56
  .amdhsa_user_sgpr_count 2
  .amdhsa_user_sgpr_kernarg_segment_ptr 1
  .amdhsa_system_sgpr_workgroup_id_x 1
  .amdhsa_float_denorm_mode_32 3
.end_amdhsa_kernel
```
